```python
import torch

def _softmax(x, axis=-1):
    return torch.softmax(x, dim=axis)
def _gelu(x):
    return torch.nn.functional.gelu(x, approximate="tanh")
def _silu(x):
    return torch.nn.functional.silu(x)
def _sigmoid(x):
    return torch.sigmoid(x)
def _layernorm(x, axis=-1, eps=1e-5):
    m = x.mean(dim=axis, keepdim=True)
    v = x.var(dim=axis, keepdim=True, unbiased=False)
    return (x - m) / torch.sqrt(v + eps)
def _scatter_add(tgt, idx, src, axis=0):
    return tgt.clone().index_add_(axis, idx, src)
def _segment_sum(src, seg, n):
    out = torch.zeros((n,) + src.shape[1:], dtype=src.dtype)
    return out.index_add_(0, seg, src)
def _pad(x, pw):
    flat = tuple(v for pair in reversed(pw) for v in pair)
    return torch.nn.functional.pad(x, flat)

kernel_name = 'concat_heads__gqa_block_cached__compressed_kv_cla__decode'

def setup_inputs():

    _w = (lambda a: (lambda t: t.to(torch.bfloat16) if t.is_floating_point() else t)(torch.as_tensor(a)))
    def _A_setup():
        B, Sq, D = 2, 1, 576
        Hq, Hkv, Sk, Dh = 32, 16, 4096, 128
        assert Hq % Hkv == 0, (Hq, Hkv)
        return {
            "x": _w((lambda *s: torch.randn(*s, dtype=torch.bfloat16) * 1.6)(B, Sq, D)),
            "k_cache": _w((lambda *s: torch.randn(*s, dtype=torch.bfloat16) * 1.6)(B, Hkv, Sk, Dh)),
            "v_cache": _w((lambda *s: torch.randn(*s, dtype=torch.bfloat16) * 0.05)(B, Hkv, Sk, Dh)),
            "wq": _w((lambda *s: torch.randn(*s, dtype=torch.bfloat16) * 1.6)(D, Hq * Dh) * (D ** -0.5)),
            "wo": _w((lambda *s: torch.randn(*s, dtype=torch.bfloat16) * 0.05)(Hq * Dh, D) * ((Hq * Dh) ** -0.5)),
        }
    _A_in = _A_setup()

    def _B_setup():
        B, H, Sq, Sk, D, M = 2, 32, 1, 4096, 128, 576
        Dc = 4 * D
        return {
            "x": _w((lambda *s: torch.randn(*s, dtype=torch.bfloat16) * 3.2)(B, Sq, M)),
            "c_kv": _w((lambda *s: torch.randn(*s, dtype=torch.bfloat16) * 0.1)(B, Sk, Dc)),
            "w_q": _w((lambda *s: torch.randn(*s, dtype=torch.bfloat16) * 6.4)(M, H, D) * (M ** -0.5)),
            "w_uk": _w((lambda *s: torch.randn(*s, dtype=torch.bfloat16) * 6.4)(Dc, H, D) * (Dc ** -0.5)),
            "w_uv": _w((lambda *s: torch.randn(*s, dtype=torch.bfloat16) * 0.1)(Dc, H, D) * (Dc ** -0.5)),
            "w_o": _w((lambda *s: torch.randn(*s, dtype=torch.bfloat16) * 0.1)(H, D, M) * ((H * D) ** -0.5)),
        }
    _B_in = _B_setup()

    return {
        "A_x": _A_in["x"],
        "A_k_cache": _A_in["k_cache"],
        "A_v_cache": _A_in["v_cache"],
        "A_wq": _A_in["wq"],
        "A_wo": _A_in["wo"],
        "B_x": _B_in["x"],
        "B_c_kv": _B_in["c_kv"],
        "B_w_q": _B_in["w_q"],
        "B_w_uk": _B_in["w_uk"],
        "B_w_uv": _B_in["w_uv"],
        "B_w_o": _B_in["w_o"],
    }

def reference(A_x, A_k_cache, A_v_cache, A_wq, A_wo, B_x, B_c_kv, B_w_q, B_w_uk, B_w_uv, B_w_o):
    def _A_ref(x, k_cache, v_cache, wq, wo):
        B, Sq, D = x.shape
        Hq, Dh = 32, 128
        Hkv = k_cache.shape[1]
        rep = Hq // Hkv
        q = (lambda x, *d: x.permute(*d))((x @ wq).reshape(B, Sq, Hq, Dh), 0, 2, 1, 3)
        k = (lambda x, n, axis: torch.repeat_interleave(x, n, dim=axis))(k_cache, rep, axis=1)
        v = (lambda x, n, axis: torch.repeat_interleave(x, n, dim=axis))(v_cache, rep, axis=1)
        scores = torch.einsum("bhqd,bhkd->bhqk", q, k) * (Dh ** -0.5)
        p = _softmax(scores, axis=-1)
        o = torch.einsum("bhqk,bhkd->bhqd", p, v)
        return (lambda x, *d: x.permute(*d))(o, 0, 2, 1, 3).reshape(B, Sq, Hq * Dh) @ wo

    def _B_ref(x, c_kv, w_q, w_uk, w_uv, w_o):
        B, Sq, M = x.shape[0], x.shape[1], x.shape[2]
        Sk = c_kv.shape[1]
        H, D = w_q.shape[1], w_q.shape[2]
        q = torch.einsum("bqm,mhd->bhqd", x, w_q)
        k = torch.einsum("bkc,chd->bhkd", c_kv, w_uk)
        v = torch.einsum("bkc,chd->bhkd", c_kv, w_uv)
        scores = torch.einsum("bhqd,bhkd->bhqk", q, k) * (D ** -0.5)
        off = Sk - Sq
        qi = torch.arange(Sq)[:, None]
        kj = torch.arange(Sk)[None, :]
        cmask = kj <= (qi + off)
        scores = torch.where(cmask[None, None], scores, -1e9)
        p = _softmax(scores, axis=-1)
        ctx = torch.einsum("bhqk,bhkd->bhqd", p, v)
        return torch.einsum("bhqd,hdm->bqm", ctx, w_o)

    a = _A_ref(A_x, A_k_cache, A_v_cache, A_wq, A_wo)
    b = _B_ref(B_x, B_c_kv, B_w_q, B_w_uk, B_w_uv, B_w_o)
    return torch.concatenate([a, b], axis=-1)
```

```asm
; @launch grid=(256,1,1) block=(512,1,1) lds=106496
.amdgcn_target "amdgcn-amd-amdhsa--gfx950"
.text
.globl concat_heads__gqa_block_cached__compressed_kv_cla__decode_kernel
.p2align 8
.type concat_heads__gqa_block_cached__compressed_kv_cla__decode_kernel,@function
concat_heads__gqa_block_cached__compressed_kv_cla__decode_kernel:
    s_cmp_ge_u32 s2, 256
    s_cbranch_scc1 END
    s_load_dwordx16 s[68:83], s[0:1], 0
    s_load_dwordx8 s[84:91], s[0:1], 64
    s_load_dwordx4 s[92:95], s[0:1], 96
    v_lshrrev_b32 v1, 6, v0
    v_and_b32 v2, 63, v0
    v_lshrrev_b32 v3, 4, v2
    v_and_b32 v4, 15, v2
    v_mov_b32 v12, 0x7fffff00
    v_mov_b32 v13, 0x7fffff00
    v_mov_b32 v14, 0x7fffff00
    v_mov_b32 v15, 0x7fffff00
    v_readfirstlane_b32 s60, v1
    s_mov_b32 s61, 0x3e0293ee
    s_waitcnt lgkmcnt(0)
    s_cmp_lt_u32 s2, 128
    s_cselect_b64 s[4:5], s[68:69], s[78:79]
    s_cselect_b64 s[6:7], s[74:75], s[82:83]
    s_cselect_b64 s[52:53], s[76:77], s[88:89]
    s_mov_b32 s8, s4
    s_and_b32 s9, s5, 0xffff
    s_mov_b32 s10, 2304
    s_mov_b32 s11, 0x00020000
    s_mov_b32 s12, s6
    s_and_b32 s13, s7, 0xffff
    s_mov_b32 s14, 4718592
    s_mov_b32 s15, 0x00020000
    s_mov_b32 s16, s84
    s_and_b32 s17, s85, 0xffff
    s_mov_b32 s18, 4194304
    s_mov_b32 s19, 0x00020000
    s_mov_b32 s20, s70
    s_and_b32 s21, s71, 0xffff
    s_mov_b32 s22, 33554432
    s_mov_b32 s23, 0x00020000
    s_mov_b32 s24, s72
    s_and_b32 s25, s73, 0xffff
    s_mov_b32 s26, 33554432
    s_mov_b32 s27, 0x00020000
    s_mov_b32 s28, s80
    s_and_b32 s29, s81, 0xffff
    s_mov_b32 s30, 8388608
    s_mov_b32 s31, 0x00020000
    s_mov_b32 s32, s94
    s_and_b32 s33, s95, 0xffff
    s_mov_b32 s34, 8388608
    s_mov_b32 s35, 0x00020000
    s_mov_b32 s36, s92
    s_and_b32 s37, s93, 0xffff
    s_mov_b32 s38, 256
    s_mov_b32 s39, 0x00020000
    s_mov_b32 s40, s52
    s_and_b32 s41, s53, 0xffff
    s_mov_b32 s42, 4718592
    s_mov_b32 s43, 0x00020000
    s_mov_b32 s44, s86
    s_and_b32 s45, s87, 0xffff
    s_mov_b32 s46, 4194304
    s_mov_b32 s47, 0x00020000
    s_mov_b32 s48, s90
    s_and_b32 s49, s91, 0xffff
    s_mov_b32 s50, 4608
    s_mov_b32 s51, 0x00020000
    s_add_u32 s100, s94, 7864320
    s_addc_u32 s101, s95, 0
    s_cmp_lg_u32 s2, 0
    s_cbranch_scc1 INI_1
    s_cmp_lg_u32 s60, 0
    s_cbranch_scc1 INI_1
    v_lshlrev_b32 v5, 7, v2
    v_add_u32 v5, 7864320, v5
    v_mov_b32 v6, 0
    buffer_store_dword v6, v5, s[32:35], 0 offen sc1
    s_waitcnt vmcnt(0)
    s_mov_b64 exec, 1
    v_mov_b32 v5, 1
    v_mov_b32 v6, 0
    buffer_atomic_add v5, v6, s[36:39], 0 offen
    s_mov_b64 exec, -1
INI_1:
    s_and_b32 s3, s2, 127
    s_lshl_b32 s54, s3, 6
    v_lshrrev_b32 v7, 2, v0
    v_and_b32 v8, 3, v0
    s_cmp_ge_u32 s2, 128
    s_cbranch_scc1 P1L_SKIP
    v_lshlrev_b32 v9, 13, v7
    v_lshl_add_u32 v9, v8, 4, v9
    v_add_u32 v9, s54, v9
    v_lshlrev_b32 v10, 1, v7
    s_mov_b32 s55, 0
    buffer_load_dwordx4 v[16:19], v9, s[12:15], s55 offen nt
    s_add_u32 s55, s55, 1048576
    buffer_load_dwordx4 v[20:23], v9, s[12:15], s55 offen nt
    s_add_u32 s55, s55, 1048576
    buffer_load_dwordx4 v[24:27], v9, s[12:15], s55 offen nt
    s_add_u32 s55, s55, 1048576
    buffer_load_dwordx4 v[28:31], v9, s[12:15], s55 offen nt
    s_add_u32 s55, s55, 1048576
    buffer_load_dwordx4 v[32:35], v9, s[12:15], s55 offen nt
    s_add_u32 s55, s55, 1048576
    buffer_load_ushort v36, v10, s[8:11], 0 offen offset:0
    buffer_load_ushort v37, v10, s[8:11], 0 offen offset:1152
    buffer_load_ushort v38, v10, s[8:11], 0 offen offset:256
    buffer_load_ushort v39, v10, s[8:11], 0 offen offset:1408
    buffer_load_ushort v40, v10, s[8:11], 0 offen offset:512
    buffer_load_ushort v41, v10, s[8:11], 0 offen offset:1664
    buffer_load_ushort v42, v10, s[8:11], 0 offen offset:768
    buffer_load_ushort v43, v10, s[8:11], 0 offen offset:1920
    buffer_load_ushort v44, v10, s[8:11], 0 offen offset:1024
    buffer_load_ushort v45, v10, s[8:11], 0 offen offset:2176
P1L_SKIP:
    s_cmp_ge_u32 s2, 192
    s_cbranch_scc1 ROLE_B
    s_mul_hi_u32 s96, s2, 715827883
    s_mul_i32 s97, s96, 6
    s_sub_u32 s97, s2, s97
    s_lshl_b32 s55, s96, 20
    s_mul_i32 s58, s97, 172032
    s_add_u32 s55, s55, s58
    s_sub_u32 s58, s60, 1
    s_mul_i32 s58, s58, 24576
    s_add_u32 s55, s55, s58
    s_mov_b32 s98, 6
    s_cmp_lg_u32 s60, 0
    s_cbranch_scc1 AROLE_OK
    s_lshl_b32 s55, s96, 20
    s_add_u32 s55, s55, 1032192
    s_cmp_eq_u32 s97, 0
    s_cselect_b32 s98, 4, 0
AROLE_OK:
    v_lshlrev_b32 v13, 8, v4
    v_lshl_add_u32 v13, v3, 4, v13
    v_add_u32 v13, s55, v13
    v_lshlrev_b32 v12, 4, v2
    v_add_u32 v12, s55, v12
    s_branch PF_DONE
ROLE_B:
    s_sub_u32 s96, s2, 192
    s_lshl_b32 s55, s96, 17
    s_sub_u32 s58, s60, 1
    s_max_i32 s58, s58, 0
    s_mul_i32 s58, s58, 9216
    s_add_u32 s55, s55, s58
    v_lshlrev_b32 v12, 4, v2
    v_add_u32 v12, s55, v12
PF_DONE:
    s_cmp_ge_u32 s2, 128
    s_cbranch_scc1 P1_DONE
    v_mov_b32 v46, 0
    v_mov_b32 v47, 0
    v_mov_b32 v48, 0
    v_mov_b32 v49, 0
    v_mov_b32 v50, 0
    v_mov_b32 v51, 0
    v_mov_b32 v52, 0
    v_mov_b32 v53, 0
    v_mov_b32 v54, 0
    v_mov_b32 v55, 0
    v_mov_b32 v56, 0
    v_mov_b32 v57, 0
    v_mov_b32 v58, 0
    v_mov_b32 v59, 0
    v_mov_b32 v60, 0
    v_mov_b32 v61, 0
    s_waitcnt vmcnt(0)
P1GO:
    v_lshlrev_b32 v36, 16, v36
    v_lshlrev_b32 v37, 16, v37
    v_lshlrev_b32 v38, 16, v38
    v_lshlrev_b32 v39, 16, v39
    v_lshlrev_b32 v40, 16, v40
    v_lshlrev_b32 v41, 16, v41
    v_lshlrev_b32 v42, 16, v42
    v_lshlrev_b32 v43, 16, v43
    v_lshlrev_b32 v44, 16, v44
    v_lshlrev_b32 v45, 16, v45
    v_lshlrev_b32 v62, 16, v16
    v_and_b32 v63, 0xffff0000, v16
    v_fmac_f32 v46, v36, v62
    v_fmac_f32 v47, v36, v63
    v_fmac_f32 v54, v37, v62
    v_fmac_f32 v55, v37, v63
    v_lshlrev_b32 v62, 16, v17
    v_and_b32 v63, 0xffff0000, v17
    v_fmac_f32 v48, v36, v62
    v_fmac_f32 v49, v36, v63
    v_fmac_f32 v56, v37, v62
    v_fmac_f32 v57, v37, v63
    v_lshlrev_b32 v62, 16, v18
    v_and_b32 v63, 0xffff0000, v18
    v_fmac_f32 v50, v36, v62
    v_fmac_f32 v51, v36, v63
    v_fmac_f32 v58, v37, v62
    v_fmac_f32 v59, v37, v63
    v_lshlrev_b32 v62, 16, v19
    v_and_b32 v63, 0xffff0000, v19
    v_fmac_f32 v52, v36, v62
    v_fmac_f32 v53, v36, v63
    v_fmac_f32 v60, v37, v62
    v_fmac_f32 v61, v37, v63
    v_lshlrev_b32 v62, 16, v20
    v_and_b32 v63, 0xffff0000, v20
    v_fmac_f32 v46, v38, v62
    v_fmac_f32 v47, v38, v63
    v_fmac_f32 v54, v39, v62
    v_fmac_f32 v55, v39, v63
    v_lshlrev_b32 v62, 16, v21
    v_and_b32 v63, 0xffff0000, v21
    v_fmac_f32 v48, v38, v62
    v_fmac_f32 v49, v38, v63
    v_fmac_f32 v56, v39, v62
    v_fmac_f32 v57, v39, v63
    v_lshlrev_b32 v62, 16, v22
    v_and_b32 v63, 0xffff0000, v22
    v_fmac_f32 v50, v38, v62
    v_fmac_f32 v51, v38, v63
    v_fmac_f32 v58, v39, v62
    v_fmac_f32 v59, v39, v63
    v_lshlrev_b32 v62, 16, v23
    v_and_b32 v63, 0xffff0000, v23
    v_fmac_f32 v52, v38, v62
    v_fmac_f32 v53, v38, v63
    v_fmac_f32 v60, v39, v62
    v_fmac_f32 v61, v39, v63
    v_lshlrev_b32 v62, 16, v24
    v_and_b32 v63, 0xffff0000, v24
    v_fmac_f32 v46, v40, v62
    v_fmac_f32 v47, v40, v63
    v_fmac_f32 v54, v41, v62
    v_fmac_f32 v55, v41, v63
    v_lshlrev_b32 v62, 16, v25
    v_and_b32 v63, 0xffff0000, v25
    v_fmac_f32 v48, v40, v62
    v_fmac_f32 v49, v40, v63
    v_fmac_f32 v56, v41, v62
    v_fmac_f32 v57, v41, v63
    v_lshlrev_b32 v62, 16, v26
    v_and_b32 v63, 0xffff0000, v26
    v_fmac_f32 v50, v40, v62
    v_fmac_f32 v51, v40, v63
    v_fmac_f32 v58, v41, v62
    v_fmac_f32 v59, v41, v63
    v_lshlrev_b32 v62, 16, v27
    v_and_b32 v63, 0xffff0000, v27
    v_fmac_f32 v52, v40, v62
    v_fmac_f32 v53, v40, v63
    v_fmac_f32 v60, v41, v62
    v_fmac_f32 v61, v41, v63
    v_lshlrev_b32 v62, 16, v28
    v_and_b32 v63, 0xffff0000, v28
    v_fmac_f32 v46, v42, v62
    v_fmac_f32 v47, v42, v63
    v_fmac_f32 v54, v43, v62
    v_fmac_f32 v55, v43, v63
    v_lshlrev_b32 v62, 16, v29
    v_and_b32 v63, 0xffff0000, v29
    v_fmac_f32 v48, v42, v62
    v_fmac_f32 v49, v42, v63
    v_fmac_f32 v56, v43, v62
    v_fmac_f32 v57, v43, v63
    v_lshlrev_b32 v62, 16, v30
    v_and_b32 v63, 0xffff0000, v30
    v_fmac_f32 v50, v42, v62
    v_fmac_f32 v51, v42, v63
    v_fmac_f32 v58, v43, v62
    v_fmac_f32 v59, v43, v63
    v_lshlrev_b32 v62, 16, v31
    v_and_b32 v63, 0xffff0000, v31
    v_fmac_f32 v52, v42, v62
    v_fmac_f32 v53, v42, v63
    v_fmac_f32 v60, v43, v62
    v_fmac_f32 v61, v43, v63
    v_lshlrev_b32 v62, 16, v32
    v_and_b32 v63, 0xffff0000, v32
    v_fmac_f32 v46, v44, v62
    v_fmac_f32 v47, v44, v63
    v_fmac_f32 v54, v45, v62
    v_fmac_f32 v55, v45, v63
    v_lshlrev_b32 v62, 16, v33
    v_and_b32 v63, 0xffff0000, v33
    v_fmac_f32 v48, v44, v62
    v_fmac_f32 v49, v44, v63
    v_fmac_f32 v56, v45, v62
    v_fmac_f32 v57, v45, v63
    v_lshlrev_b32 v62, 16, v34
    v_and_b32 v63, 0xffff0000, v34
    v_fmac_f32 v50, v44, v62
    v_fmac_f32 v51, v44, v63
    v_fmac_f32 v58, v45, v62
    v_fmac_f32 v59, v45, v63
    v_lshlrev_b32 v62, 16, v35
    v_and_b32 v63, 0xffff0000, v35
    v_fmac_f32 v52, v44, v62
    v_fmac_f32 v53, v44, v63
    v_fmac_f32 v60, v45, v62
    v_fmac_f32 v61, v45, v63
    s_nop 1
    v_add_f32_dpp v46, v46, v46 row_ror:4 row_mask:0xf bank_mask:0xf
    v_add_f32_dpp v47, v47, v47 row_ror:4 row_mask:0xf bank_mask:0xf
    v_add_f32_dpp v48, v48, v48 row_ror:4 row_mask:0xf bank_mask:0xf
    v_add_f32_dpp v49, v49, v49 row_ror:4 row_mask:0xf bank_mask:0xf
    v_add_f32_dpp v50, v50, v50 row_ror:4 row_mask:0xf bank_mask:0xf
    v_add_f32_dpp v51, v51, v51 row_ror:4 row_mask:0xf bank_mask:0xf
    v_add_f32_dpp v52, v52, v52 row_ror:4 row_mask:0xf bank_mask:0xf
    v_add_f32_dpp v53, v53, v53 row_ror:4 row_mask:0xf bank_mask:0xf
    v_add_f32_dpp v54, v54, v54 row_ror:4 row_mask:0xf bank_mask:0xf
    v_add_f32_dpp v55, v55, v55 row_ror:4 row_mask:0xf bank_mask:0xf
    v_add_f32_dpp v56, v56, v56 row_ror:4 row_mask:0xf bank_mask:0xf
    v_add_f32_dpp v57, v57, v57 row_ror:4 row_mask:0xf bank_mask:0xf
    v_add_f32_dpp v58, v58, v58 row_ror:4 row_mask:0xf bank_mask:0xf
    v_add_f32_dpp v59, v59, v59 row_ror:4 row_mask:0xf bank_mask:0xf
    v_add_f32_dpp v60, v60, v60 row_ror:4 row_mask:0xf bank_mask:0xf
    v_add_f32_dpp v61, v61, v61 row_ror:4 row_mask:0xf bank_mask:0xf
    s_nop 1
    v_add_f32_dpp v46, v46, v46 row_ror:8 row_mask:0xf bank_mask:0xf
    v_add_f32_dpp v47, v47, v47 row_ror:8 row_mask:0xf bank_mask:0xf
    v_add_f32_dpp v48, v48, v48 row_ror:8 row_mask:0xf bank_mask:0xf
    v_add_f32_dpp v49, v49, v49 row_ror:8 row_mask:0xf bank_mask:0xf
    v_add_f32_dpp v50, v50, v50 row_ror:8 row_mask:0xf bank_mask:0xf
    v_add_f32_dpp v51, v51, v51 row_ror:8 row_mask:0xf bank_mask:0xf
    v_add_f32_dpp v52, v52, v52 row_ror:8 row_mask:0xf bank_mask:0xf
    v_add_f32_dpp v53, v53, v53 row_ror:8 row_mask:0xf bank_mask:0xf
    v_add_f32_dpp v54, v54, v54 row_ror:8 row_mask:0xf bank_mask:0xf
    v_add_f32_dpp v55, v55, v55 row_ror:8 row_mask:0xf bank_mask:0xf
    v_add_f32_dpp v56, v56, v56 row_ror:8 row_mask:0xf bank_mask:0xf
    v_add_f32_dpp v57, v57, v57 row_ror:8 row_mask:0xf bank_mask:0xf
    v_add_f32_dpp v58, v58, v58 row_ror:8 row_mask:0xf bank_mask:0xf
    v_add_f32_dpp v59, v59, v59 row_ror:8 row_mask:0xf bank_mask:0xf
    v_add_f32_dpp v60, v60, v60 row_ror:8 row_mask:0xf bank_mask:0xf
    v_add_f32_dpp v61, v61, v61 row_ror:8 row_mask:0xf bank_mask:0xf
    v_lshrrev_b32 v5, 4, v0
    v_lshlrev_b32 v5, 8, v5
    v_lshl_add_u32 v5, v8, 6, v5
    v_cmp_gt_u32 vcc, 4, v4
    s_and_saveexec_b64 s[62:63], vcc
    ds_write_b128 v5, v[46:49] offset:0
    ds_write_b128 v5, v[50:53] offset:16
    ds_write_b128 v5, v[54:57] offset:32
    ds_write_b128 v5, v[58:61] offset:48
    s_mov_b64 exec, s[62:63]
    s_waitcnt lgkmcnt(0)
    s_barrier
    s_cmp_lg_u32 s60, 0
    s_cbranch_scc1 W0E_2
    v_lshlrev_b32 v5, 2, v0
    ds_read_b32 v16, v5 offset:0
    ds_read_b32 v17, v5 offset:256
    ds_read_b32 v18, v5 offset:512
    ds_read_b32 v19, v5 offset:768
    ds_read_b32 v20, v5 offset:1024
    ds_read_b32 v21, v5 offset:1280
    ds_read_b32 v22, v5 offset:1536
    ds_read_b32 v23, v5 offset:1792
    ds_read_b32 v24, v5 offset:2048
    ds_read_b32 v25, v5 offset:2304
    ds_read_b32 v26, v5 offset:2560
    ds_read_b32 v27, v5 offset:2816
    ds_read_b32 v28, v5 offset:3072
    ds_read_b32 v29, v5 offset:3328
    ds_read_b32 v30, v5 offset:3584
    ds_read_b32 v31, v5 offset:3840
    ds_read_b32 v32, v5 offset:4096
    ds_read_b32 v33, v5 offset:4352
    ds_read_b32 v34, v5 offset:4608
    ds_read_b32 v35, v5 offset:4864
    ds_read_b32 v36, v5 offset:5120
    ds_read_b32 v37, v5 offset:5376
    ds_read_b32 v38, v5 offset:5632
    ds_read_b32 v39, v5 offset:5888
    ds_read_b32 v40, v5 offset:6144
    ds_read_b32 v41, v5 offset:6400
    ds_read_b32 v42, v5 offset:6656
    ds_read_b32 v43, v5 offset:6912
    ds_read_b32 v44, v5 offset:7168
    ds_read_b32 v45, v5 offset:7424
    ds_read_b32 v46, v5 offset:7680
    ds_read_b32 v47, v5 offset:7936
    s_waitcnt lgkmcnt(0)
    v_add_f32 v16, v16, v17
    v_add_f32 v16, v16, v18
    v_add_f32 v16, v16, v19
    v_add_f32 v16, v16, v20
    v_add_f32 v16, v16, v21
    v_add_f32 v16, v16, v22
    v_add_f32 v16, v16, v23
    v_add_f32 v16, v16, v24
    v_add_f32 v16, v16, v25
    v_add_f32 v16, v16, v26
    v_add_f32 v16, v16, v27
    v_add_f32 v16, v16, v28
    v_add_f32 v16, v16, v29
    v_add_f32 v16, v16, v30
    v_add_f32 v16, v16, v31
    v_add_f32 v16, v16, v32
    v_add_f32 v16, v16, v33
    v_add_f32 v16, v16, v34
    v_add_f32 v16, v16, v35
    v_add_f32 v16, v16, v36
    v_add_f32 v16, v16, v37
    v_add_f32 v16, v16, v38
    v_add_f32 v16, v16, v39
    v_add_f32 v16, v16, v40
    v_add_f32 v16, v16, v41
    v_add_f32 v16, v16, v42
    v_add_f32 v16, v16, v43
    v_add_f32 v16, v16, v44
    v_add_f32 v16, v16, v45
    v_add_f32 v16, v16, v46
    v_add_f32 v16, v16, v47
    v_cvt_pk_bf16_f32 v16, v16, v16
    v_lshlrev_b32 v5, 4, v3
    v_and_b32 v6, 7, v0
    v_lshl_add_u32 v5, v6, 1, v5
    v_bfe_u32 v6, v0, 3, 1
    v_lshl_add_u32 v5, v6, 13, v5
    s_lshr_b32 s55, s2, 7
    s_lshl_b32 s55, s55, 14
    s_add_u32 s55, s55, s54
    buffer_store_short v16, v5, s[32:35], s55 offen sc1
    s_waitcnt vmcnt(0)
    s_lshr_b32 s55, s2, 3
    s_lshl_b32 s55, s55, 2
    s_sub_u32 s58, s2, 128
    s_lshr_b32 s58, s58, 2
    s_lshl_b32 s58, s58, 2
    s_add_u32 s58, s58, 64
    s_cmp_lt_u32 s2, 128
    s_cselect_b32 s55, s55, s58
    s_mov_b32 s59, s55
    s_mov_b64 s[62:63], exec
    s_mov_b64 exec, 1
    v_mov_b32 v6, 0
    s_mov_b32 s64, 0
POLL_3:
    buffer_load_dword v5, v6, s[36:39], 0 offen sc1
    s_waitcnt vmcnt(0)
    v_cmp_le_u32 vcc, 1, v5
    s_nop 3
    s_cmp_eq_u64 vcc, exec
    s_cbranch_scc1 PDONE_4
    s_add_u32 s64, s64, 1
    s_cmp_gt_u32 s64, 0x20000
    s_cbranch_scc1 PDONE_4
    s_sleep 2
    s_branch POLL_3
PDONE_4:
    s_mov_b64 exec, s[62:63]
    s_mov_b32 s55, s59
    s_mov_b64 s[62:63], exec
    s_mov_b64 exec, 1
    v_mov_b32 v5, 1
    v_mov_b32 v6, s55
    v_lshlrev_b32 v6, 5, v6
    v_add_u32 v6, 7864320, v6
    buffer_atomic_add v5, v6, s[32:35], 0 offen
    s_mov_b64 exec, s[62:63]
W0E_2:
P1_DONE:
    s_cmp_ge_u32 s2, 192
    s_cbranch_scc1 ATT_B
    s_cmp_eq_u32 s60, 0
    s_cbranch_scc1 AK_SKIP
    s_cmp_gt_u32 s98, 0
    s_mov_b32 s55, 0
    s_cselect_b32 s55, s55, 0x7fff0000
    buffer_load_dwordx4 v[64:67], v13, s[20:23], s55 offen offset:0 nt
    buffer_load_dwordx4 v[68:71], v13, s[20:23], s55 offen offset:64 nt
    buffer_load_dwordx4 v[72:75], v13, s[20:23], s55 offen offset:128 nt
    buffer_load_dwordx4 v[76:79], v13, s[20:23], s55 offen offset:192 nt
    s_cmp_gt_u32 s98, 1
    s_mov_b32 s55, 4096
    s_cselect_b32 s55, s55, 0x7fff0000
    buffer_load_dwordx4 v[80:83], v13, s[20:23], s55 offen offset:0 nt
    buffer_load_dwordx4 v[84:87], v13, s[20:23], s55 offen offset:64 nt
    buffer_load_dwordx4 v[88:91], v13, s[20:23], s55 offen offset:128 nt
    buffer_load_dwordx4 v[92:95], v13, s[20:23], s55 offen offset:192 nt
    s_cmp_gt_u32 s98, 2
    s_mov_b32 s55, 8192
    s_cselect_b32 s55, s55, 0x7fff0000
    buffer_load_dwordx4 v[96:99], v13, s[20:23], s55 offen offset:0 nt
    buffer_load_dwordx4 v[100:103], v13, s[20:23], s55 offen offset:64 nt
    buffer_load_dwordx4 v[104:107], v13, s[20:23], s55 offen offset:128 nt
    buffer_load_dwordx4 v[108:111], v13, s[20:23], s55 offen offset:192 nt
    s_cmp_gt_u32 s98, 3
    s_mov_b32 s55, 12288
    s_cselect_b32 s55, s55, 0x7fff0000
    buffer_load_dwordx4 v[112:115], v13, s[20:23], s55 offen offset:0 nt
    buffer_load_dwordx4 v[116:119], v13, s[20:23], s55 offen offset:64 nt
    buffer_load_dwordx4 v[120:123], v13, s[20:23], s55 offen offset:128 nt
    buffer_load_dwordx4 v[124:127], v13, s[20:23], s55 offen offset:192 nt
    s_cmp_gt_u32 s98, 4
    s_mov_b32 s55, 16384
    s_cselect_b32 s55, s55, 0x7fff0000
    buffer_load_dwordx4 v[128:131], v13, s[20:23], s55 offen offset:0 nt
    buffer_load_dwordx4 v[132:135], v13, s[20:23], s55 offen offset:64 nt
    buffer_load_dwordx4 v[136:139], v13, s[20:23], s55 offen offset:128 nt
    buffer_load_dwordx4 v[140:143], v13, s[20:23], s55 offen offset:192 nt
    s_cmp_gt_u32 s98, 5
    s_mov_b32 s55, 20480
    s_cselect_b32 s55, s55, 0x7fff0000
    buffer_load_dwordx4 v[144:147], v13, s[20:23], s55 offen offset:0 nt
    buffer_load_dwordx4 v[148:151], v13, s[20:23], s55 offen offset:64 nt
    buffer_load_dwordx4 v[152:155], v13, s[20:23], s55 offen offset:128 nt
    buffer_load_dwordx4 v[156:159], v13, s[20:23], s55 offen offset:192 nt
    s_cmp_gt_u32 s98, 0
    s_mov_b32 s55, 0
    s_cselect_b32 s55, s55, 0x7fff0000
    buffer_load_dwordx4 v[160:163], v12, s[24:27], s55 offen offset:0 nt
    buffer_load_dwordx4 v[164:167], v12, s[24:27], s55 offen offset:1024 nt
    buffer_load_dwordx4 v[168:171], v12, s[24:27], s55 offen offset:2048 nt
    buffer_load_dwordx4 v[172:175], v12, s[24:27], s55 offen offset:3072 nt
    s_cmp_gt_u32 s98, 1
    s_mov_b32 s55, 4096
    s_cselect_b32 s55, s55, 0x7fff0000
    buffer_load_dwordx4 v[176:179], v12, s[24:27], s55 offen offset:0 nt
    buffer_load_dwordx4 v[180:183], v12, s[24:27], s55 offen offset:1024 nt
    buffer_load_dwordx4 v[184:187], v12, s[24:27], s55 offen offset:2048 nt
    buffer_load_dwordx4 v[188:191], v12, s[24:27], s55 offen offset:3072 nt
    s_cmp_gt_u32 s98, 2
    s_mov_b32 s55, 8192
    s_cselect_b32 s55, s55, 0x7fff0000
    buffer_load_dwordx4 v[192:195], v12, s[24:27], s55 offen offset:0 nt
    buffer_load_dwordx4 v[196:199], v12, s[24:27], s55 offen offset:1024 nt
    buffer_load_dwordx4 v[200:203], v12, s[24:27], s55 offen offset:2048 nt
    buffer_load_dwordx4 v[204:207], v12, s[24:27], s55 offen offset:3072 nt
    s_cmp_gt_u32 s98, 3
    s_mov_b32 s55, 12288
    s_cselect_b32 s55, s55, 0x7fff0000
    buffer_load_dwordx4 v[208:211], v12, s[24:27], s55 offen offset:0 nt
    buffer_load_dwordx4 v[212:215], v12, s[24:27], s55 offen offset:1024 nt
    buffer_load_dwordx4 v[216:219], v12, s[24:27], s55 offen offset:2048 nt
    buffer_load_dwordx4 v[220:223], v12, s[24:27], s55 offen offset:3072 nt
    s_cmp_gt_u32 s98, 4
    s_mov_b32 s55, 16384
    s_cselect_b32 s55, s55, 0x7fff0000
    buffer_load_dwordx4 v[224:227], v12, s[24:27], s55 offen offset:0 nt
    buffer_load_dwordx4 v[228:231], v12, s[24:27], s55 offen offset:1024 nt
    buffer_load_dwordx4 v[232:235], v12, s[24:27], s55 offen offset:2048 nt
    buffer_load_dwordx4 v[236:239], v12, s[24:27], s55 offen offset:3072 nt
    s_cmp_gt_u32 s98, 5
    s_mov_b32 s55, 20480
    s_cselect_b32 s55, s55, 0x7fff0000
    buffer_load_dwordx4 v[240:243], v12, s[24:27], s55 offen offset:0 nt
    buffer_load_dwordx4 v[244:247], v12, s[24:27], s55 offen offset:1024 nt
    buffer_load_dwordx4 v[248:251], v12, s[24:27], s55 offen offset:2048 nt
    buffer_load_dwordx4 v[252:255], v12, s[24:27], s55 offen offset:3072 nt
AK_SKIP:
    s_cmp_lg_u32 s60, 0
    s_cbranch_scc1 W0E_5
    s_mov_b64 s[62:63], exec
    s_mov_b64 exec, 1
    v_mov_b32 v6, 0
    s_mov_b32 s64, 0
POLL_6:
    buffer_load_dword v5, v6, s[36:39], 0 offen sc1
    s_waitcnt vmcnt(0)
    v_cmp_le_u32 vcc, 1, v5
    s_nop 3
    s_cmp_eq_u64 vcc, exec
    s_cbranch_scc1 PDONE_7
    s_add_u32 s64, s64, 1
    s_cmp_gt_u32 s64, 0x20000
    s_cbranch_scc1 PDONE_7
    s_sleep 2
    s_branch POLL_6
PDONE_7:
    s_mov_b64 exec, s[62:63]
    s_and_b32 s55, s96, 15
    s_lshl_b32 s55, s55, 2
    s_mov_b64 s[62:63], exec
    s_mov_b64 exec, 1
    v_lshlrev_b32 v6, 2, v2
    v_add_u32 v6, s55, v6
    v_lshlrev_b32 v6, 5, v6
    v_add_u32 v6, 7864320, v6
    s_mov_b32 s64, 0
POLL_8:
    buffer_load_dword v5, v6, s[32:35], 0 offen sc1
    s_waitcnt vmcnt(0)
    v_cmp_le_u32 vcc, 8, v5
    s_nop 3
    s_cmp_eq_u64 vcc, exec
    s_cbranch_scc1 PDONE_9
    s_add_u32 s64, s64, 1
    s_cmp_gt_u32 s64, 0x20000
    s_cbranch_scc1 PDONE_9
    s_sleep 2
    s_branch POLL_8
PDONE_9:
    s_mov_b64 exec, s[62:63]
    s_cmp_gt_u32 s98, 0
    s_mov_b32 s55, 0
    s_cselect_b32 s55, s55, 0x7fff0000
    buffer_load_dwordx4 v[64:67], v13, s[20:23], s55 offen offset:0 nt
    buffer_load_dwordx4 v[68:71], v13, s[20:23], s55 offen offset:64 nt
    buffer_load_dwordx4 v[72:75], v13, s[20:23], s55 offen offset:128 nt
    buffer_load_dwordx4 v[76:79], v13, s[20:23], s55 offen offset:192 nt
    s_cmp_gt_u32 s98, 1
    s_mov_b32 s55, 4096
    s_cselect_b32 s55, s55, 0x7fff0000
    buffer_load_dwordx4 v[80:83], v13, s[20:23], s55 offen offset:0 nt
    buffer_load_dwordx4 v[84:87], v13, s[20:23], s55 offen offset:64 nt
    buffer_load_dwordx4 v[88:91], v13, s[20:23], s55 offen offset:128 nt
    buffer_load_dwordx4 v[92:95], v13, s[20:23], s55 offen offset:192 nt
    s_cmp_gt_u32 s98, 2
    s_mov_b32 s55, 8192
    s_cselect_b32 s55, s55, 0x7fff0000
    buffer_load_dwordx4 v[96:99], v13, s[20:23], s55 offen offset:0 nt
    buffer_load_dwordx4 v[100:103], v13, s[20:23], s55 offen offset:64 nt
    buffer_load_dwordx4 v[104:107], v13, s[20:23], s55 offen offset:128 nt
    buffer_load_dwordx4 v[108:111], v13, s[20:23], s55 offen offset:192 nt
    s_cmp_gt_u32 s98, 3
    s_mov_b32 s55, 12288
    s_cselect_b32 s55, s55, 0x7fff0000
    buffer_load_dwordx4 v[112:115], v13, s[20:23], s55 offen offset:0 nt
    buffer_load_dwordx4 v[116:119], v13, s[20:23], s55 offen offset:64 nt
    buffer_load_dwordx4 v[120:123], v13, s[20:23], s55 offen offset:128 nt
    buffer_load_dwordx4 v[124:127], v13, s[20:23], s55 offen offset:192 nt
    s_cmp_gt_u32 s98, 4
    s_mov_b32 s55, 16384
    s_cselect_b32 s55, s55, 0x7fff0000
    buffer_load_dwordx4 v[128:131], v13, s[20:23], s55 offen offset:0 nt
    buffer_load_dwordx4 v[132:135], v13, s[20:23], s55 offen offset:64 nt
    buffer_load_dwordx4 v[136:139], v13, s[20:23], s55 offen offset:128 nt
    buffer_load_dwordx4 v[140:143], v13, s[20:23], s55 offen offset:192 nt
    s_cmp_gt_u32 s98, 5
    s_mov_b32 s55, 20480
    s_cselect_b32 s55, s55, 0x7fff0000
    buffer_load_dwordx4 v[144:147], v13, s[20:23], s55 offen offset:0 nt
    buffer_load_dwordx4 v[148:151], v13, s[20:23], s55 offen offset:64 nt
    buffer_load_dwordx4 v[152:155], v13, s[20:23], s55 offen offset:128 nt
    buffer_load_dwordx4 v[156:159], v13, s[20:23], s55 offen offset:192 nt
    s_cmp_gt_u32 s98, 0
    s_mov_b32 s55, 0
    s_cselect_b32 s55, s55, 0x7fff0000
    buffer_load_dwordx4 v[160:163], v12, s[24:27], s55 offen offset:0 nt
    buffer_load_dwordx4 v[164:167], v12, s[24:27], s55 offen offset:1024 nt
    buffer_load_dwordx4 v[168:171], v12, s[24:27], s55 offen offset:2048 nt
    buffer_load_dwordx4 v[172:175], v12, s[24:27], s55 offen offset:3072 nt
    s_cmp_gt_u32 s98, 1
    s_mov_b32 s55, 4096
    s_cselect_b32 s55, s55, 0x7fff0000
    buffer_load_dwordx4 v[176:179], v12, s[24:27], s55 offen offset:0 nt
    buffer_load_dwordx4 v[180:183], v12, s[24:27], s55 offen offset:1024 nt
    buffer_load_dwordx4 v[184:187], v12, s[24:27], s55 offen offset:2048 nt
    buffer_load_dwordx4 v[188:191], v12, s[24:27], s55 offen offset:3072 nt
    s_cmp_gt_u32 s98, 2
    s_mov_b32 s55, 8192
    s_cselect_b32 s55, s55, 0x7fff0000
    buffer_load_dwordx4 v[192:195], v12, s[24:27], s55 offen offset:0 nt
    buffer_load_dwordx4 v[196:199], v12, s[24:27], s55 offen offset:1024 nt
    buffer_load_dwordx4 v[200:203], v12, s[24:27], s55 offen offset:2048 nt
    buffer_load_dwordx4 v[204:207], v12, s[24:27], s55 offen offset:3072 nt
    s_cmp_gt_u32 s98, 3
    s_mov_b32 s55, 12288
    s_cselect_b32 s55, s55, 0x7fff0000
    buffer_load_dwordx4 v[208:211], v12, s[24:27], s55 offen offset:0 nt
    buffer_load_dwordx4 v[212:215], v12, s[24:27], s55 offen offset:1024 nt
    buffer_load_dwordx4 v[216:219], v12, s[24:27], s55 offen offset:2048 nt
    buffer_load_dwordx4 v[220:223], v12, s[24:27], s55 offen offset:3072 nt
    s_cmp_gt_u32 s98, 4
    s_mov_b32 s55, 16384
    s_cselect_b32 s55, s55, 0x7fff0000
    buffer_load_dwordx4 v[224:227], v12, s[24:27], s55 offen offset:0 nt
    buffer_load_dwordx4 v[228:231], v12, s[24:27], s55 offen offset:1024 nt
    buffer_load_dwordx4 v[232:235], v12, s[24:27], s55 offen offset:2048 nt
    buffer_load_dwordx4 v[236:239], v12, s[24:27], s55 offen offset:3072 nt
    s_cmp_gt_u32 s98, 5
    s_mov_b32 s55, 20480
    s_cselect_b32 s55, s55, 0x7fff0000
    buffer_load_dwordx4 v[240:243], v12, s[24:27], s55 offen offset:0 nt
    buffer_load_dwordx4 v[244:247], v12, s[24:27], s55 offen offset:1024 nt
    buffer_load_dwordx4 v[248:251], v12, s[24:27], s55 offen offset:2048 nt
    buffer_load_dwordx4 v[252:255], v12, s[24:27], s55 offen offset:3072 nt
W0E_5:
    s_barrier
    v_lshlrev_b32 v5, 8, v4
    v_lshl_add_u32 v5, v3, 4, v5
    s_lshl_b32 s55, s96, 9
    v_cmp_gt_u32 vcc, 2, v4
    v_mov_b32 v6, 0x7fffff00
    s_nop 1
    v_cndmask_b32 v5, v6, v5, vcc
    buffer_load_dwordx4 v[16:19], v5, s[32:35], s55 offen offset:0 sc1
    buffer_load_dwordx4 v[20:23], v5, s[32:35], s55 offen offset:64 sc1
    buffer_load_dwordx4 v[24:27], v5, s[32:35], s55 offen offset:128 sc1
    buffer_load_dwordx4 v[28:31], v5, s[32:35], s55 offen offset:192 sc1
    s_waitcnt vmcnt(0)
    v_mfma_f32_16x16x32_bf16 v[32:35], v[16:19], v[64:67], 0
    v_mfma_f32_16x16x32_bf16 v[32:35], v[20:23], v[68:71], v[32:35]
    v_mfma_f32_16x16x32_bf16 v[32:35], v[24:27], v[72:75], v[32:35]
    v_mfma_f32_16x16x32_bf16 v[32:35], v[28:31], v[76:79], v[32:35]
    v_mfma_f32_16x16x32_bf16 v[36:39], v[16:19], v[80:83], 0
    v_mfma_f32_16x16x32_bf16 v[36:39], v[20:23], v[84:87], v[36:39]
    v_mfma_f32_16x16x32_bf16 v[36:39], v[24:27], v[88:91], v[36:39]
    v_mfma_f32_16x16x32_bf16 v[36:39], v[28:31], v[92:95], v[36:39]
    v_mfma_f32_16x16x32_bf16 v[40:43], v[16:19], v[96:99], 0
    v_mfma_f32_16x16x32_bf16 v[40:43], v[20:23], v[100:103], v[40:43]
    v_mfma_f32_16x16x32_bf16 v[40:43], v[24:27], v[104:107], v[40:43]
    v_mfma_f32_16x16x32_bf16 v[40:43], v[28:31], v[108:111], v[40:43]
    v_mfma_f32_16x16x32_bf16 v[44:47], v[16:19], v[112:115], 0
    v_mfma_f32_16x16x32_bf16 v[44:47], v[20:23], v[116:119], v[44:47]
    v_mfma_f32_16x16x32_bf16 v[44:47], v[24:27], v[120:123], v[44:47]
    v_mfma_f32_16x16x32_bf16 v[44:47], v[28:31], v[124:127], v[44:47]
    v_mfma_f32_16x16x32_bf16 v[48:51], v[16:19], v[128:131], 0
    v_mfma_f32_16x16x32_bf16 v[48:51], v[20:23], v[132:135], v[48:51]
    v_mfma_f32_16x16x32_bf16 v[48:51], v[24:27], v[136:139], v[48:51]
    v_mfma_f32_16x16x32_bf16 v[48:51], v[28:31], v[140:143], v[48:51]
    v_mfma_f32_16x16x32_bf16 v[52:55], v[16:19], v[144:147], 0
    v_mfma_f32_16x16x32_bf16 v[52:55], v[20:23], v[148:151], v[52:55]
    v_mfma_f32_16x16x32_bf16 v[52:55], v[24:27], v[152:155], v[52:55]
    v_mfma_f32_16x16x32_bf16 v[52:55], v[28:31], v[156:159], v[52:55]
    s_nop 7
    s_nop 3
    s_cmp_gt_u32 s98, 0
    s_cselect_b32 s55, 0, 0xff800000
    v_add_f32 v32, s55, v32
    v_add_f32 v33, s55, v33
    s_cmp_gt_u32 s98, 1
    s_cselect_b32 s55, 0, 0xff800000
    v_add_f32 v36, s55, v36
    v_add_f32 v37, s55, v37
    s_cmp_gt_u32 s98, 2
    s_cselect_b32 s55, 0, 0xff800000
    v_add_f32 v40, s55, v40
    v_add_f32 v41, s55, v41
    s_cmp_gt_u32 s98, 3
    s_cselect_b32 s55, 0, 0xff800000
    v_add_f32 v44, s55, v44
    v_add_f32 v45, s55, v45
    s_cmp_gt_u32 s98, 4
    s_cselect_b32 s55, 0, 0xff800000
    v_add_f32 v48, s55, v48
    v_add_f32 v49, s55, v49
    s_cmp_gt_u32 s98, 5
    s_cselect_b32 s55, 0, 0xff800000
    v_add_f32 v52, s55, v52
    v_add_f32 v53, s55, v53
    v_max3_f32 v8, v32, v36, v40
    v_max3_f32 v8, v8, v44, v48
    v_max_f32 v8, v8, v52
    v_max_f32 v8, 0xf149f2ca, v8
    v_max3_f32 v9, v33, v37, v41
    v_max3_f32 v9, v9, v45, v49
    v_max_f32 v9, v9, v53
    v_max_f32 v9, 0xf149f2ca, v9
    s_nop 1
    v_max_f32_dpp v8, v8, v8 row_ror:8 row_mask:0xf bank_mask:0xf
    v_max_f32_dpp v9, v9, v9 row_ror:8 row_mask:0xf bank_mask:0xf
    s_nop 1
    v_max_f32_dpp v8, v8, v8 row_ror:4 row_mask:0xf bank_mask:0xf
    v_max_f32_dpp v9, v9, v9 row_ror:4 row_mask:0xf bank_mask:0xf
    s_nop 1
    v_max_f32_dpp v8, v8, v8 row_ror:2 row_mask:0xf bank_mask:0xf
    v_max_f32_dpp v9, v9, v9 row_ror:2 row_mask:0xf bank_mask:0xf
    s_nop 1
    v_max_f32_dpp v8, v8, v8 row_ror:1 row_mask:0xf bank_mask:0xf
    v_max_f32_dpp v9, v9, v9 row_ror:1 row_mask:0xf bank_mask:0xf
    s_nop 1
    v_sub_f32 v32, v32, v8
    v_mul_f32 v32, s61, v32
    v_sub_f32 v36, v36, v8
    v_mul_f32 v36, s61, v36
    v_sub_f32 v40, v40, v8
    v_mul_f32 v40, s61, v40
    v_sub_f32 v44, v44, v8
    v_mul_f32 v44, s61, v44
    v_sub_f32 v48, v48, v8
    v_mul_f32 v48, s61, v48
    v_sub_f32 v52, v52, v8
    v_mul_f32 v52, s61, v52
    v_sub_f32 v33, v33, v9
    v_mul_f32 v33, s61, v33
    v_sub_f32 v37, v37, v9
    v_mul_f32 v37, s61, v37
    v_sub_f32 v41, v41, v9
    v_mul_f32 v41, s61, v41
    v_sub_f32 v45, v45, v9
    v_mul_f32 v45, s61, v45
    v_sub_f32 v49, v49, v9
    v_mul_f32 v49, s61, v49
    v_sub_f32 v53, v53, v9
    v_mul_f32 v53, s61, v53
    v_exp_f32 v32, v32
    v_exp_f32 v36, v36
    v_exp_f32 v40, v40
    v_exp_f32 v44, v44
    v_exp_f32 v48, v48
    v_exp_f32 v52, v52
    v_exp_f32 v33, v33
    v_exp_f32 v37, v37
    v_exp_f32 v41, v41
    v_exp_f32 v45, v45
    v_exp_f32 v49, v49
    v_exp_f32 v53, v53
    s_nop 0
    v_add_f32 v10, v32, v36
    v_add_f32 v7, v40, v44
    v_add_f32 v10, v10, v7
    v_add_f32 v7, v48, v52
    v_add_f32 v10, v10, v7
    v_add_f32 v11, v33, v37
    v_add_f32 v7, v41, v45
    v_add_f32 v11, v11, v7
    v_add_f32 v7, v49, v53
    v_add_f32 v11, v11, v7
    s_nop 1
    v_add_f32_dpp v10, v10, v10 row_ror:8 row_mask:0xf bank_mask:0xf
    v_add_f32_dpp v11, v11, v11 row_ror:8 row_mask:0xf bank_mask:0xf
    s_nop 1
    v_add_f32_dpp v10, v10, v10 row_ror:4 row_mask:0xf bank_mask:0xf
    v_add_f32_dpp v11, v11, v11 row_ror:4 row_mask:0xf bank_mask:0xf
    s_nop 1
    v_add_f32_dpp v10, v10, v10 row_ror:2 row_mask:0xf bank_mask:0xf
    v_add_f32_dpp v11, v11, v11 row_ror:2 row_mask:0xf bank_mask:0xf
    s_nop 1
    v_add_f32_dpp v10, v10, v10 row_ror:1 row_mask:0xf bank_mask:0xf
    v_add_f32_dpp v11, v11, v11 row_ror:1 row_mask:0xf bank_mask:0xf
    v_mul_u32_u24 v5, 768, v1
    v_lshl_add_u32 v5, v2, 3, v5
    v_cmp_gt_u32 vcc, 16, v2
    s_and_saveexec_b64 s[62:63], vcc
    ds_write_b64 v5, v[32:33] offset:10240
    ds_write_b64 v5, v[36:37] offset:10368
    ds_write_b64 v5, v[40:41] offset:10496
    ds_write_b64 v5, v[44:45] offset:10624
    ds_write_b64 v5, v[48:49] offset:10752
    ds_write_b64 v5, v[52:53] offset:10880
    v_lshlrev_b32 v6, 4, v1
    ds_write_b128 v6, v[8:11] offset:16384
    s_mov_b64 exec, s[62:63]
    v_mov_b32 v56, 0
    v_mov_b32 v57, 0
    v_mov_b32 v58, 0
    v_mov_b32 v59, 0
    v_mov_b32 v60, 0
    v_mov_b32 v61, 0
    v_mov_b32 v62, 0
    v_mov_b32 v63, 0
    v_mov_b32 v64, 0
    v_mov_b32 v65, 0
    v_mov_b32 v66, 0
    v_mov_b32 v67, 0
    v_mov_b32 v68, 0
    v_mov_b32 v69, 0
    v_mov_b32 v70, 0
    v_mov_b32 v71, 0
    s_waitcnt lgkmcnt(0)
    v_mul_u32_u24 v5, 768, v1
    v_lshl_add_u32 v5, v3, 3, v5
    ds_read_b64 v[96:97], v5 offset:10240
    ds_read_b64 v[98:99], v5 offset:10272
    ds_read_b64 v[100:101], v5 offset:10304
    ds_read_b64 v[102:103], v5 offset:10336
    ds_read_b64 v[104:105], v5 offset:10368
    ds_read_b64 v[106:107], v5 offset:10400
    ds_read_b64 v[108:109], v5 offset:10432
    ds_read_b64 v[110:111], v5 offset:10464
    ds_read_b64 v[112:113], v5 offset:10496
    ds_read_b64 v[114:115], v5 offset:10528
    ds_read_b64 v[116:117], v5 offset:10560
    ds_read_b64 v[118:119], v5 offset:10592
    s_waitcnt lgkmcnt(11)
    v_lshlrev_b32 v6, 16, v160
    v_and_b32 v7, 0xffff0000, v160
    v_pk_fma_f32 v[56:57], v[6:7], v[96:97], v[56:57] op_sel:[0,0,0] op_sel_hi:[1,0,1]
    v_pk_fma_f32 v[64:65], v[6:7], v[96:97], v[64:65] op_sel:[0,1,0] op_sel_hi:[1,1,1]
    v_lshlrev_b32 v6, 16, v161
    v_and_b32 v7, 0xffff0000, v161
    v_pk_fma_f32 v[58:59], v[6:7], v[96:97], v[58:59] op_sel:[0,0,0] op_sel_hi:[1,0,1]
    v_pk_fma_f32 v[66:67], v[6:7], v[96:97], v[66:67] op_sel:[0,1,0] op_sel_hi:[1,1,1]
    v_lshlrev_b32 v6, 16, v162
    v_and_b32 v7, 0xffff0000, v162
    v_pk_fma_f32 v[60:61], v[6:7], v[96:97], v[60:61] op_sel:[0,0,0] op_sel_hi:[1,0,1]
    v_pk_fma_f32 v[68:69], v[6:7], v[96:97], v[68:69] op_sel:[0,1,0] op_sel_hi:[1,1,1]
    v_lshlrev_b32 v6, 16, v163
    v_and_b32 v7, 0xffff0000, v163
    v_pk_fma_f32 v[62:63], v[6:7], v[96:97], v[62:63] op_sel:[0,0,0] op_sel_hi:[1,0,1]
    v_pk_fma_f32 v[70:71], v[6:7], v[96:97], v[70:71] op_sel:[0,1,0] op_sel_hi:[1,1,1]
    s_waitcnt lgkmcnt(10)
    v_lshlrev_b32 v6, 16, v164
    v_and_b32 v7, 0xffff0000, v164
    v_pk_fma_f32 v[56:57], v[6:7], v[98:99], v[56:57] op_sel:[0,0,0] op_sel_hi:[1,0,1]
    v_pk_fma_f32 v[64:65], v[6:7], v[98:99], v[64:65] op_sel:[0,1,0] op_sel_hi:[1,1,1]
    v_lshlrev_b32 v6, 16, v165
    v_and_b32 v7, 0xffff0000, v165
    v_pk_fma_f32 v[58:59], v[6:7], v[98:99], v[58:59] op_sel:[0,0,0] op_sel_hi:[1,0,1]
    v_pk_fma_f32 v[66:67], v[6:7], v[98:99], v[66:67] op_sel:[0,1,0] op_sel_hi:[1,1,1]
    v_lshlrev_b32 v6, 16, v166
    v_and_b32 v7, 0xffff0000, v166
    v_pk_fma_f32 v[60:61], v[6:7], v[98:99], v[60:61] op_sel:[0,0,0] op_sel_hi:[1,0,1]
    v_pk_fma_f32 v[68:69], v[6:7], v[98:99], v[68:69] op_sel:[0,1,0] op_sel_hi:[1,1,1]
    v_lshlrev_b32 v6, 16, v167
    v_and_b32 v7, 0xffff0000, v167
    v_pk_fma_f32 v[62:63], v[6:7], v[98:99], v[62:63] op_sel:[0,0,0] op_sel_hi:[1,0,1]
    v_pk_fma_f32 v[70:71], v[6:7], v[98:99], v[70:71] op_sel:[0,1,0] op_sel_hi:[1,1,1]
    s_waitcnt lgkmcnt(9)
    v_lshlrev_b32 v6, 16, v168
    v_and_b32 v7, 0xffff0000, v168
    v_pk_fma_f32 v[56:57], v[6:7], v[100:101], v[56:57] op_sel:[0,0,0] op_sel_hi:[1,0,1]
    v_pk_fma_f32 v[64:65], v[6:7], v[100:101], v[64:65] op_sel:[0,1,0] op_sel_hi:[1,1,1]
    v_lshlrev_b32 v6, 16, v169
    v_and_b32 v7, 0xffff0000, v169
    v_pk_fma_f32 v[58:59], v[6:7], v[100:101], v[58:59] op_sel:[0,0,0] op_sel_hi:[1,0,1]
    v_pk_fma_f32 v[66:67], v[6:7], v[100:101], v[66:67] op_sel:[0,1,0] op_sel_hi:[1,1,1]
    v_lshlrev_b32 v6, 16, v170
    v_and_b32 v7, 0xffff0000, v170
    v_pk_fma_f32 v[60:61], v[6:7], v[100:101], v[60:61] op_sel:[0,0,0] op_sel_hi:[1,0,1]
    v_pk_fma_f32 v[68:69], v[6:7], v[100:101], v[68:69] op_sel:[0,1,0] op_sel_hi:[1,1,1]
    v_lshlrev_b32 v6, 16, v171
    v_and_b32 v7, 0xffff0000, v171
    v_pk_fma_f32 v[62:63], v[6:7], v[100:101], v[62:63] op_sel:[0,0,0] op_sel_hi:[1,0,1]
    v_pk_fma_f32 v[70:71], v[6:7], v[100:101], v[70:71] op_sel:[0,1,0] op_sel_hi:[1,1,1]
    s_waitcnt lgkmcnt(8)
    v_lshlrev_b32 v6, 16, v172
    v_and_b32 v7, 0xffff0000, v172
    v_pk_fma_f32 v[56:57], v[6:7], v[102:103], v[56:57] op_sel:[0,0,0] op_sel_hi:[1,0,1]
    v_pk_fma_f32 v[64:65], v[6:7], v[102:103], v[64:65] op_sel:[0,1,0] op_sel_hi:[1,1,1]
    v_lshlrev_b32 v6, 16, v173
    v_and_b32 v7, 0xffff0000, v173
    v_pk_fma_f32 v[58:59], v[6:7], v[102:103], v[58:59] op_sel:[0,0,0] op_sel_hi:[1,0,1]
    v_pk_fma_f32 v[66:67], v[6:7], v[102:103], v[66:67] op_sel:[0,1,0] op_sel_hi:[1,1,1]
    v_lshlrev_b32 v6, 16, v174
    v_and_b32 v7, 0xffff0000, v174
    v_pk_fma_f32 v[60:61], v[6:7], v[102:103], v[60:61] op_sel:[0,0,0] op_sel_hi:[1,0,1]
    v_pk_fma_f32 v[68:69], v[6:7], v[102:103], v[68:69] op_sel:[0,1,0] op_sel_hi:[1,1,1]
    v_lshlrev_b32 v6, 16, v175
    v_and_b32 v7, 0xffff0000, v175
    v_pk_fma_f32 v[62:63], v[6:7], v[102:103], v[62:63] op_sel:[0,0,0] op_sel_hi:[1,0,1]
    v_pk_fma_f32 v[70:71], v[6:7], v[102:103], v[70:71] op_sel:[0,1,0] op_sel_hi:[1,1,1]
    s_waitcnt lgkmcnt(7)
    v_lshlrev_b32 v6, 16, v176
    v_and_b32 v7, 0xffff0000, v176
    v_pk_fma_f32 v[56:57], v[6:7], v[104:105], v[56:57] op_sel:[0,0,0] op_sel_hi:[1,0,1]
    v_pk_fma_f32 v[64:65], v[6:7], v[104:105], v[64:65] op_sel:[0,1,0] op_sel_hi:[1,1,1]
    v_lshlrev_b32 v6, 16, v177
    v_and_b32 v7, 0xffff0000, v177
    v_pk_fma_f32 v[58:59], v[6:7], v[104:105], v[58:59] op_sel:[0,0,0] op_sel_hi:[1,0,1]
    v_pk_fma_f32 v[66:67], v[6:7], v[104:105], v[66:67] op_sel:[0,1,0] op_sel_hi:[1,1,1]
    v_lshlrev_b32 v6, 16, v178
    v_and_b32 v7, 0xffff0000, v178
    v_pk_fma_f32 v[60:61], v[6:7], v[104:105], v[60:61] op_sel:[0,0,0] op_sel_hi:[1,0,1]
    v_pk_fma_f32 v[68:69], v[6:7], v[104:105], v[68:69] op_sel:[0,1,0] op_sel_hi:[1,1,1]
    v_lshlrev_b32 v6, 16, v179
    v_and_b32 v7, 0xffff0000, v179
    v_pk_fma_f32 v[62:63], v[6:7], v[104:105], v[62:63] op_sel:[0,0,0] op_sel_hi:[1,0,1]
    v_pk_fma_f32 v[70:71], v[6:7], v[104:105], v[70:71] op_sel:[0,1,0] op_sel_hi:[1,1,1]
    s_waitcnt lgkmcnt(6)
    v_lshlrev_b32 v6, 16, v180
    v_and_b32 v7, 0xffff0000, v180
    v_pk_fma_f32 v[56:57], v[6:7], v[106:107], v[56:57] op_sel:[0,0,0] op_sel_hi:[1,0,1]
    v_pk_fma_f32 v[64:65], v[6:7], v[106:107], v[64:65] op_sel:[0,1,0] op_sel_hi:[1,1,1]
    v_lshlrev_b32 v6, 16, v181
    v_and_b32 v7, 0xffff0000, v181
    v_pk_fma_f32 v[58:59], v[6:7], v[106:107], v[58:59] op_sel:[0,0,0] op_sel_hi:[1,0,1]
    v_pk_fma_f32 v[66:67], v[6:7], v[106:107], v[66:67] op_sel:[0,1,0] op_sel_hi:[1,1,1]
    v_lshlrev_b32 v6, 16, v182
    v_and_b32 v7, 0xffff0000, v182
    v_pk_fma_f32 v[60:61], v[6:7], v[106:107], v[60:61] op_sel:[0,0,0] op_sel_hi:[1,0,1]
    v_pk_fma_f32 v[68:69], v[6:7], v[106:107], v[68:69] op_sel:[0,1,0] op_sel_hi:[1,1,1]
    v_lshlrev_b32 v6, 16, v183
    v_and_b32 v7, 0xffff0000, v183
    v_pk_fma_f32 v[62:63], v[6:7], v[106:107], v[62:63] op_sel:[0,0,0] op_sel_hi:[1,0,1]
    v_pk_fma_f32 v[70:71], v[6:7], v[106:107], v[70:71] op_sel:[0,1,0] op_sel_hi:[1,1,1]
    s_waitcnt lgkmcnt(5)
    v_lshlrev_b32 v6, 16, v184
    v_and_b32 v7, 0xffff0000, v184
    v_pk_fma_f32 v[56:57], v[6:7], v[108:109], v[56:57] op_sel:[0,0,0] op_sel_hi:[1,0,1]
    v_pk_fma_f32 v[64:65], v[6:7], v[108:109], v[64:65] op_sel:[0,1,0] op_sel_hi:[1,1,1]
    v_lshlrev_b32 v6, 16, v185
    v_and_b32 v7, 0xffff0000, v185
    v_pk_fma_f32 v[58:59], v[6:7], v[108:109], v[58:59] op_sel:[0,0,0] op_sel_hi:[1,0,1]
    v_pk_fma_f32 v[66:67], v[6:7], v[108:109], v[66:67] op_sel:[0,1,0] op_sel_hi:[1,1,1]
    v_lshlrev_b32 v6, 16, v186
    v_and_b32 v7, 0xffff0000, v186
    v_pk_fma_f32 v[60:61], v[6:7], v[108:109], v[60:61] op_sel:[0,0,0] op_sel_hi:[1,0,1]
    v_pk_fma_f32 v[68:69], v[6:7], v[108:109], v[68:69] op_sel:[0,1,0] op_sel_hi:[1,1,1]
    v_lshlrev_b32 v6, 16, v187
    v_and_b32 v7, 0xffff0000, v187
    v_pk_fma_f32 v[62:63], v[6:7], v[108:109], v[62:63] op_sel:[0,0,0] op_sel_hi:[1,0,1]
    v_pk_fma_f32 v[70:71], v[6:7], v[108:109], v[70:71] op_sel:[0,1,0] op_sel_hi:[1,1,1]
    s_waitcnt lgkmcnt(4)
    v_lshlrev_b32 v6, 16, v188
    v_and_b32 v7, 0xffff0000, v188
    v_pk_fma_f32 v[56:57], v[6:7], v[110:111], v[56:57] op_sel:[0,0,0] op_sel_hi:[1,0,1]
    v_pk_fma_f32 v[64:65], v[6:7], v[110:111], v[64:65] op_sel:[0,1,0] op_sel_hi:[1,1,1]
    v_lshlrev_b32 v6, 16, v189
    v_and_b32 v7, 0xffff0000, v189
    v_pk_fma_f32 v[58:59], v[6:7], v[110:111], v[58:59] op_sel:[0,0,0] op_sel_hi:[1,0,1]
    v_pk_fma_f32 v[66:67], v[6:7], v[110:111], v[66:67] op_sel:[0,1,0] op_sel_hi:[1,1,1]
    v_lshlrev_b32 v6, 16, v190
    v_and_b32 v7, 0xffff0000, v190
    v_pk_fma_f32 v[60:61], v[6:7], v[110:111], v[60:61] op_sel:[0,0,0] op_sel_hi:[1,0,1]
    v_pk_fma_f32 v[68:69], v[6:7], v[110:111], v[68:69] op_sel:[0,1,0] op_sel_hi:[1,1,1]
    v_lshlrev_b32 v6, 16, v191
    v_and_b32 v7, 0xffff0000, v191
    v_pk_fma_f32 v[62:63], v[6:7], v[110:111], v[62:63] op_sel:[0,0,0] op_sel_hi:[1,0,1]
    v_pk_fma_f32 v[70:71], v[6:7], v[110:111], v[70:71] op_sel:[0,1,0] op_sel_hi:[1,1,1]
    s_waitcnt lgkmcnt(3)
    v_lshlrev_b32 v6, 16, v192
    v_and_b32 v7, 0xffff0000, v192
    v_pk_fma_f32 v[56:57], v[6:7], v[112:113], v[56:57] op_sel:[0,0,0] op_sel_hi:[1,0,1]
    v_pk_fma_f32 v[64:65], v[6:7], v[112:113], v[64:65] op_sel:[0,1,0] op_sel_hi:[1,1,1]
    v_lshlrev_b32 v6, 16, v193
    v_and_b32 v7, 0xffff0000, v193
    v_pk_fma_f32 v[58:59], v[6:7], v[112:113], v[58:59] op_sel:[0,0,0] op_sel_hi:[1,0,1]
    v_pk_fma_f32 v[66:67], v[6:7], v[112:113], v[66:67] op_sel:[0,1,0] op_sel_hi:[1,1,1]
    v_lshlrev_b32 v6, 16, v194
    v_and_b32 v7, 0xffff0000, v194
    v_pk_fma_f32 v[60:61], v[6:7], v[112:113], v[60:61] op_sel:[0,0,0] op_sel_hi:[1,0,1]
    v_pk_fma_f32 v[68:69], v[6:7], v[112:113], v[68:69] op_sel:[0,1,0] op_sel_hi:[1,1,1]
    v_lshlrev_b32 v6, 16, v195
    v_and_b32 v7, 0xffff0000, v195
    v_pk_fma_f32 v[62:63], v[6:7], v[112:113], v[62:63] op_sel:[0,0,0] op_sel_hi:[1,0,1]
    v_pk_fma_f32 v[70:71], v[6:7], v[112:113], v[70:71] op_sel:[0,1,0] op_sel_hi:[1,1,1]
    s_waitcnt lgkmcnt(2)
    v_lshlrev_b32 v6, 16, v196
    v_and_b32 v7, 0xffff0000, v196
    v_pk_fma_f32 v[56:57], v[6:7], v[114:115], v[56:57] op_sel:[0,0,0] op_sel_hi:[1,0,1]
    v_pk_fma_f32 v[64:65], v[6:7], v[114:115], v[64:65] op_sel:[0,1,0] op_sel_hi:[1,1,1]
    v_lshlrev_b32 v6, 16, v197
    v_and_b32 v7, 0xffff0000, v197
    v_pk_fma_f32 v[58:59], v[6:7], v[114:115], v[58:59] op_sel:[0,0,0] op_sel_hi:[1,0,1]
    v_pk_fma_f32 v[66:67], v[6:7], v[114:115], v[66:67] op_sel:[0,1,0] op_sel_hi:[1,1,1]
    v_lshlrev_b32 v6, 16, v198
    v_and_b32 v7, 0xffff0000, v198
    v_pk_fma_f32 v[60:61], v[6:7], v[114:115], v[60:61] op_sel:[0,0,0] op_sel_hi:[1,0,1]
    v_pk_fma_f32 v[68:69], v[6:7], v[114:115], v[68:69] op_sel:[0,1,0] op_sel_hi:[1,1,1]
    v_lshlrev_b32 v6, 16, v199
    v_and_b32 v7, 0xffff0000, v199
    v_pk_fma_f32 v[62:63], v[6:7], v[114:115], v[62:63] op_sel:[0,0,0] op_sel_hi:[1,0,1]
    v_pk_fma_f32 v[70:71], v[6:7], v[114:115], v[70:71] op_sel:[0,1,0] op_sel_hi:[1,1,1]
    s_waitcnt lgkmcnt(1)
    v_lshlrev_b32 v6, 16, v200
    v_and_b32 v7, 0xffff0000, v200
    v_pk_fma_f32 v[56:57], v[6:7], v[116:117], v[56:57] op_sel:[0,0,0] op_sel_hi:[1,0,1]
    v_pk_fma_f32 v[64:65], v[6:7], v[116:117], v[64:65] op_sel:[0,1,0] op_sel_hi:[1,1,1]
    v_lshlrev_b32 v6, 16, v201
    v_and_b32 v7, 0xffff0000, v201
    v_pk_fma_f32 v[58:59], v[6:7], v[116:117], v[58:59] op_sel:[0,0,0] op_sel_hi:[1,0,1]
    v_pk_fma_f32 v[66:67], v[6:7], v[116:117], v[66:67] op_sel:[0,1,0] op_sel_hi:[1,1,1]
    v_lshlrev_b32 v6, 16, v202
    v_and_b32 v7, 0xffff0000, v202
    v_pk_fma_f32 v[60:61], v[6:7], v[116:117], v[60:61] op_sel:[0,0,0] op_sel_hi:[1,0,1]
    v_pk_fma_f32 v[68:69], v[6:7], v[116:117], v[68:69] op_sel:[0,1,0] op_sel_hi:[1,1,1]
    v_lshlrev_b32 v6, 16, v203
    v_and_b32 v7, 0xffff0000, v203
    v_pk_fma_f32 v[62:63], v[6:7], v[116:117], v[62:63] op_sel:[0,0,0] op_sel_hi:[1,0,1]
    v_pk_fma_f32 v[70:71], v[6:7], v[116:117], v[70:71] op_sel:[0,1,0] op_sel_hi:[1,1,1]
    s_waitcnt lgkmcnt(0)
    v_lshlrev_b32 v6, 16, v204
    v_and_b32 v7, 0xffff0000, v204
    v_pk_fma_f32 v[56:57], v[6:7], v[118:119], v[56:57] op_sel:[0,0,0] op_sel_hi:[1,0,1]
    v_pk_fma_f32 v[64:65], v[6:7], v[118:119], v[64:65] op_sel:[0,1,0] op_sel_hi:[1,1,1]
    v_lshlrev_b32 v6, 16, v205
    v_and_b32 v7, 0xffff0000, v205
    v_pk_fma_f32 v[58:59], v[6:7], v[118:119], v[58:59] op_sel:[0,0,0] op_sel_hi:[1,0,1]
    v_pk_fma_f32 v[66:67], v[6:7], v[118:119], v[66:67] op_sel:[0,1,0] op_sel_hi:[1,1,1]
    v_lshlrev_b32 v6, 16, v206
    v_and_b32 v7, 0xffff0000, v206
    v_pk_fma_f32 v[60:61], v[6:7], v[118:119], v[60:61] op_sel:[0,0,0] op_sel_hi:[1,0,1]
    v_pk_fma_f32 v[68:69], v[6:7], v[118:119], v[68:69] op_sel:[0,1,0] op_sel_hi:[1,1,1]
    v_lshlrev_b32 v6, 16, v207
    v_and_b32 v7, 0xffff0000, v207
    v_pk_fma_f32 v[62:63], v[6:7], v[118:119], v[62:63] op_sel:[0,0,0] op_sel_hi:[1,0,1]
    v_pk_fma_f32 v[70:71], v[6:7], v[118:119], v[70:71] op_sel:[0,1,0] op_sel_hi:[1,1,1]
    ds_read_b64 v[96:97], v5 offset:10624
    ds_read_b64 v[98:99], v5 offset:10656
    ds_read_b64 v[100:101], v5 offset:10688
    ds_read_b64 v[102:103], v5 offset:10720
    ds_read_b64 v[104:105], v5 offset:10752
    ds_read_b64 v[106:107], v5 offset:10784
    ds_read_b64 v[108:109], v5 offset:10816
    ds_read_b64 v[110:111], v5 offset:10848
    ds_read_b64 v[112:113], v5 offset:10880
    ds_read_b64 v[114:115], v5 offset:10912
    ds_read_b64 v[116:117], v5 offset:10944
    ds_read_b64 v[118:119], v5 offset:10976
    s_waitcnt lgkmcnt(11)
    v_lshlrev_b32 v6, 16, v208
    v_and_b32 v7, 0xffff0000, v208
    v_pk_fma_f32 v[56:57], v[6:7], v[96:97], v[56:57] op_sel:[0,0,0] op_sel_hi:[1,0,1]
    v_pk_fma_f32 v[64:65], v[6:7], v[96:97], v[64:65] op_sel:[0,1,0] op_sel_hi:[1,1,1]
    v_lshlrev_b32 v6, 16, v209
    v_and_b32 v7, 0xffff0000, v209
    v_pk_fma_f32 v[58:59], v[6:7], v[96:97], v[58:59] op_sel:[0,0,0] op_sel_hi:[1,0,1]
    v_pk_fma_f32 v[66:67], v[6:7], v[96:97], v[66:67] op_sel:[0,1,0] op_sel_hi:[1,1,1]
    v_lshlrev_b32 v6, 16, v210
    v_and_b32 v7, 0xffff0000, v210
    v_pk_fma_f32 v[60:61], v[6:7], v[96:97], v[60:61] op_sel:[0,0,0] op_sel_hi:[1,0,1]
    v_pk_fma_f32 v[68:69], v[6:7], v[96:97], v[68:69] op_sel:[0,1,0] op_sel_hi:[1,1,1]
    v_lshlrev_b32 v6, 16, v211
    v_and_b32 v7, 0xffff0000, v211
    v_pk_fma_f32 v[62:63], v[6:7], v[96:97], v[62:63] op_sel:[0,0,0] op_sel_hi:[1,0,1]
    v_pk_fma_f32 v[70:71], v[6:7], v[96:97], v[70:71] op_sel:[0,1,0] op_sel_hi:[1,1,1]
    s_waitcnt lgkmcnt(10)
    v_lshlrev_b32 v6, 16, v212
    v_and_b32 v7, 0xffff0000, v212
    v_pk_fma_f32 v[56:57], v[6:7], v[98:99], v[56:57] op_sel:[0,0,0] op_sel_hi:[1,0,1]
    v_pk_fma_f32 v[64:65], v[6:7], v[98:99], v[64:65] op_sel:[0,1,0] op_sel_hi:[1,1,1]
    v_lshlrev_b32 v6, 16, v213
    v_and_b32 v7, 0xffff0000, v213
    v_pk_fma_f32 v[58:59], v[6:7], v[98:99], v[58:59] op_sel:[0,0,0] op_sel_hi:[1,0,1]
    v_pk_fma_f32 v[66:67], v[6:7], v[98:99], v[66:67] op_sel:[0,1,0] op_sel_hi:[1,1,1]
    v_lshlrev_b32 v6, 16, v214
    v_and_b32 v7, 0xffff0000, v214
    v_pk_fma_f32 v[60:61], v[6:7], v[98:99], v[60:61] op_sel:[0,0,0] op_sel_hi:[1,0,1]
    v_pk_fma_f32 v[68:69], v[6:7], v[98:99], v[68:69] op_sel:[0,1,0] op_sel_hi:[1,1,1]
    v_lshlrev_b32 v6, 16, v215
    v_and_b32 v7, 0xffff0000, v215
    v_pk_fma_f32 v[62:63], v[6:7], v[98:99], v[62:63] op_sel:[0,0,0] op_sel_hi:[1,0,1]
    v_pk_fma_f32 v[70:71], v[6:7], v[98:99], v[70:71] op_sel:[0,1,0] op_sel_hi:[1,1,1]
    s_waitcnt lgkmcnt(9)
    v_lshlrev_b32 v6, 16, v216
    v_and_b32 v7, 0xffff0000, v216
    v_pk_fma_f32 v[56:57], v[6:7], v[100:101], v[56:57] op_sel:[0,0,0] op_sel_hi:[1,0,1]
    v_pk_fma_f32 v[64:65], v[6:7], v[100:101], v[64:65] op_sel:[0,1,0] op_sel_hi:[1,1,1]
    v_lshlrev_b32 v6, 16, v217
    v_and_b32 v7, 0xffff0000, v217
    v_pk_fma_f32 v[58:59], v[6:7], v[100:101], v[58:59] op_sel:[0,0,0] op_sel_hi:[1,0,1]
    v_pk_fma_f32 v[66:67], v[6:7], v[100:101], v[66:67] op_sel:[0,1,0] op_sel_hi:[1,1,1]
    v_lshlrev_b32 v6, 16, v218
    v_and_b32 v7, 0xffff0000, v218
    v_pk_fma_f32 v[60:61], v[6:7], v[100:101], v[60:61] op_sel:[0,0,0] op_sel_hi:[1,0,1]
    v_pk_fma_f32 v[68:69], v[6:7], v[100:101], v[68:69] op_sel:[0,1,0] op_sel_hi:[1,1,1]
    v_lshlrev_b32 v6, 16, v219
    v_and_b32 v7, 0xffff0000, v219
    v_pk_fma_f32 v[62:63], v[6:7], v[100:101], v[62:63] op_sel:[0,0,0] op_sel_hi:[1,0,1]
    v_pk_fma_f32 v[70:71], v[6:7], v[100:101], v[70:71] op_sel:[0,1,0] op_sel_hi:[1,1,1]
    s_waitcnt lgkmcnt(8)
    v_lshlrev_b32 v6, 16, v220
    v_and_b32 v7, 0xffff0000, v220
    v_pk_fma_f32 v[56:57], v[6:7], v[102:103], v[56:57] op_sel:[0,0,0] op_sel_hi:[1,0,1]
    v_pk_fma_f32 v[64:65], v[6:7], v[102:103], v[64:65] op_sel:[0,1,0] op_sel_hi:[1,1,1]
    v_lshlrev_b32 v6, 16, v221
    v_and_b32 v7, 0xffff0000, v221
    v_pk_fma_f32 v[58:59], v[6:7], v[102:103], v[58:59] op_sel:[0,0,0] op_sel_hi:[1,0,1]
    v_pk_fma_f32 v[66:67], v[6:7], v[102:103], v[66:67] op_sel:[0,1,0] op_sel_hi:[1,1,1]
    v_lshlrev_b32 v6, 16, v222
    v_and_b32 v7, 0xffff0000, v222
    v_pk_fma_f32 v[60:61], v[6:7], v[102:103], v[60:61] op_sel:[0,0,0] op_sel_hi:[1,0,1]
    v_pk_fma_f32 v[68:69], v[6:7], v[102:103], v[68:69] op_sel:[0,1,0] op_sel_hi:[1,1,1]
    v_lshlrev_b32 v6, 16, v223
    v_and_b32 v7, 0xffff0000, v223
    v_pk_fma_f32 v[62:63], v[6:7], v[102:103], v[62:63] op_sel:[0,0,0] op_sel_hi:[1,0,1]
    v_pk_fma_f32 v[70:71], v[6:7], v[102:103], v[70:71] op_sel:[0,1,0] op_sel_hi:[1,1,1]
    s_waitcnt lgkmcnt(7)
    v_lshlrev_b32 v6, 16, v224
    v_and_b32 v7, 0xffff0000, v224
    v_pk_fma_f32 v[56:57], v[6:7], v[104:105], v[56:57] op_sel:[0,0,0] op_sel_hi:[1,0,1]
    v_pk_fma_f32 v[64:65], v[6:7], v[104:105], v[64:65] op_sel:[0,1,0] op_sel_hi:[1,1,1]
    v_lshlrev_b32 v6, 16, v225
    v_and_b32 v7, 0xffff0000, v225
    v_pk_fma_f32 v[58:59], v[6:7], v[104:105], v[58:59] op_sel:[0,0,0] op_sel_hi:[1,0,1]
    v_pk_fma_f32 v[66:67], v[6:7], v[104:105], v[66:67] op_sel:[0,1,0] op_sel_hi:[1,1,1]
    v_lshlrev_b32 v6, 16, v226
    v_and_b32 v7, 0xffff0000, v226
    v_pk_fma_f32 v[60:61], v[6:7], v[104:105], v[60:61] op_sel:[0,0,0] op_sel_hi:[1,0,1]
    v_pk_fma_f32 v[68:69], v[6:7], v[104:105], v[68:69] op_sel:[0,1,0] op_sel_hi:[1,1,1]
    v_lshlrev_b32 v6, 16, v227
    v_and_b32 v7, 0xffff0000, v227
    v_pk_fma_f32 v[62:63], v[6:7], v[104:105], v[62:63] op_sel:[0,0,0] op_sel_hi:[1,0,1]
    v_pk_fma_f32 v[70:71], v[6:7], v[104:105], v[70:71] op_sel:[0,1,0] op_sel_hi:[1,1,1]
    s_waitcnt lgkmcnt(6)
    v_lshlrev_b32 v6, 16, v228
    v_and_b32 v7, 0xffff0000, v228
    v_pk_fma_f32 v[56:57], v[6:7], v[106:107], v[56:57] op_sel:[0,0,0] op_sel_hi:[1,0,1]
    v_pk_fma_f32 v[64:65], v[6:7], v[106:107], v[64:65] op_sel:[0,1,0] op_sel_hi:[1,1,1]
    v_lshlrev_b32 v6, 16, v229
    v_and_b32 v7, 0xffff0000, v229
    v_pk_fma_f32 v[58:59], v[6:7], v[106:107], v[58:59] op_sel:[0,0,0] op_sel_hi:[1,0,1]
    v_pk_fma_f32 v[66:67], v[6:7], v[106:107], v[66:67] op_sel:[0,1,0] op_sel_hi:[1,1,1]
    v_lshlrev_b32 v6, 16, v230
    v_and_b32 v7, 0xffff0000, v230
    v_pk_fma_f32 v[60:61], v[6:7], v[106:107], v[60:61] op_sel:[0,0,0] op_sel_hi:[1,0,1]
    v_pk_fma_f32 v[68:69], v[6:7], v[106:107], v[68:69] op_sel:[0,1,0] op_sel_hi:[1,1,1]
    v_lshlrev_b32 v6, 16, v231
    v_and_b32 v7, 0xffff0000, v231
    v_pk_fma_f32 v[62:63], v[6:7], v[106:107], v[62:63] op_sel:[0,0,0] op_sel_hi:[1,0,1]
    v_pk_fma_f32 v[70:71], v[6:7], v[106:107], v[70:71] op_sel:[0,1,0] op_sel_hi:[1,1,1]
    s_waitcnt lgkmcnt(5)
    v_lshlrev_b32 v6, 16, v232
    v_and_b32 v7, 0xffff0000, v232
    v_pk_fma_f32 v[56:57], v[6:7], v[108:109], v[56:57] op_sel:[0,0,0] op_sel_hi:[1,0,1]
    v_pk_fma_f32 v[64:65], v[6:7], v[108:109], v[64:65] op_sel:[0,1,0] op_sel_hi:[1,1,1]
    v_lshlrev_b32 v6, 16, v233
    v_and_b32 v7, 0xffff0000, v233
    v_pk_fma_f32 v[58:59], v[6:7], v[108:109], v[58:59] op_sel:[0,0,0] op_sel_hi:[1,0,1]
    v_pk_fma_f32 v[66:67], v[6:7], v[108:109], v[66:67] op_sel:[0,1,0] op_sel_hi:[1,1,1]
    v_lshlrev_b32 v6, 16, v234
    v_and_b32 v7, 0xffff0000, v234
    v_pk_fma_f32 v[60:61], v[6:7], v[108:109], v[60:61] op_sel:[0,0,0] op_sel_hi:[1,0,1]
    v_pk_fma_f32 v[68:69], v[6:7], v[108:109], v[68:69] op_sel:[0,1,0] op_sel_hi:[1,1,1]
    v_lshlrev_b32 v6, 16, v235
    v_and_b32 v7, 0xffff0000, v235
    v_pk_fma_f32 v[62:63], v[6:7], v[108:109], v[62:63] op_sel:[0,0,0] op_sel_hi:[1,0,1]
    v_pk_fma_f32 v[70:71], v[6:7], v[108:109], v[70:71] op_sel:[0,1,0] op_sel_hi:[1,1,1]
    s_waitcnt lgkmcnt(4)
    v_lshlrev_b32 v6, 16, v236
    v_and_b32 v7, 0xffff0000, v236
    v_pk_fma_f32 v[56:57], v[6:7], v[110:111], v[56:57] op_sel:[0,0,0] op_sel_hi:[1,0,1]
    v_pk_fma_f32 v[64:65], v[6:7], v[110:111], v[64:65] op_sel:[0,1,0] op_sel_hi:[1,1,1]
    v_lshlrev_b32 v6, 16, v237
    v_and_b32 v7, 0xffff0000, v237
    v_pk_fma_f32 v[58:59], v[6:7], v[110:111], v[58:59] op_sel:[0,0,0] op_sel_hi:[1,0,1]
    v_pk_fma_f32 v[66:67], v[6:7], v[110:111], v[66:67] op_sel:[0,1,0] op_sel_hi:[1,1,1]
    v_lshlrev_b32 v6, 16, v238
    v_and_b32 v7, 0xffff0000, v238
    v_pk_fma_f32 v[60:61], v[6:7], v[110:111], v[60:61] op_sel:[0,0,0] op_sel_hi:[1,0,1]
    v_pk_fma_f32 v[68:69], v[6:7], v[110:111], v[68:69] op_sel:[0,1,0] op_sel_hi:[1,1,1]
    v_lshlrev_b32 v6, 16, v239
    v_and_b32 v7, 0xffff0000, v239
    v_pk_fma_f32 v[62:63], v[6:7], v[110:111], v[62:63] op_sel:[0,0,0] op_sel_hi:[1,0,1]
    v_pk_fma_f32 v[70:71], v[6:7], v[110:111], v[70:71] op_sel:[0,1,0] op_sel_hi:[1,1,1]
    s_waitcnt lgkmcnt(3)
    v_lshlrev_b32 v6, 16, v240
    v_and_b32 v7, 0xffff0000, v240
    v_pk_fma_f32 v[56:57], v[6:7], v[112:113], v[56:57] op_sel:[0,0,0] op_sel_hi:[1,0,1]
    v_pk_fma_f32 v[64:65], v[6:7], v[112:113], v[64:65] op_sel:[0,1,0] op_sel_hi:[1,1,1]
    v_lshlrev_b32 v6, 16, v241
    v_and_b32 v7, 0xffff0000, v241
    v_pk_fma_f32 v[58:59], v[6:7], v[112:113], v[58:59] op_sel:[0,0,0] op_sel_hi:[1,0,1]
    v_pk_fma_f32 v[66:67], v[6:7], v[112:113], v[66:67] op_sel:[0,1,0] op_sel_hi:[1,1,1]
    v_lshlrev_b32 v6, 16, v242
    v_and_b32 v7, 0xffff0000, v242
    v_pk_fma_f32 v[60:61], v[6:7], v[112:113], v[60:61] op_sel:[0,0,0] op_sel_hi:[1,0,1]
    v_pk_fma_f32 v[68:69], v[6:7], v[112:113], v[68:69] op_sel:[0,1,0] op_sel_hi:[1,1,1]
    v_lshlrev_b32 v6, 16, v243
    v_and_b32 v7, 0xffff0000, v243
    v_pk_fma_f32 v[62:63], v[6:7], v[112:113], v[62:63] op_sel:[0,0,0] op_sel_hi:[1,0,1]
    v_pk_fma_f32 v[70:71], v[6:7], v[112:113], v[70:71] op_sel:[0,1,0] op_sel_hi:[1,1,1]
    s_waitcnt lgkmcnt(2)
    v_lshlrev_b32 v6, 16, v244
    v_and_b32 v7, 0xffff0000, v244
    v_pk_fma_f32 v[56:57], v[6:7], v[114:115], v[56:57] op_sel:[0,0,0] op_sel_hi:[1,0,1]
    v_pk_fma_f32 v[64:65], v[6:7], v[114:115], v[64:65] op_sel:[0,1,0] op_sel_hi:[1,1,1]
    v_lshlrev_b32 v6, 16, v245
    v_and_b32 v7, 0xffff0000, v245
    v_pk_fma_f32 v[58:59], v[6:7], v[114:115], v[58:59] op_sel:[0,0,0] op_sel_hi:[1,0,1]
    v_pk_fma_f32 v[66:67], v[6:7], v[114:115], v[66:67] op_sel:[0,1,0] op_sel_hi:[1,1,1]
    v_lshlrev_b32 v6, 16, v246
    v_and_b32 v7, 0xffff0000, v246
    v_pk_fma_f32 v[60:61], v[6:7], v[114:115], v[60:61] op_sel:[0,0,0] op_sel_hi:[1,0,1]
    v_pk_fma_f32 v[68:69], v[6:7], v[114:115], v[68:69] op_sel:[0,1,0] op_sel_hi:[1,1,1]
    v_lshlrev_b32 v6, 16, v247
    v_and_b32 v7, 0xffff0000, v247
    v_pk_fma_f32 v[62:63], v[6:7], v[114:115], v[62:63] op_sel:[0,0,0] op_sel_hi:[1,0,1]
    v_pk_fma_f32 v[70:71], v[6:7], v[114:115], v[70:71] op_sel:[0,1,0] op_sel_hi:[1,1,1]
    s_waitcnt lgkmcnt(1)
    v_lshlrev_b32 v6, 16, v248
    v_and_b32 v7, 0xffff0000, v248
    v_pk_fma_f32 v[56:57], v[6:7], v[116:117], v[56:57] op_sel:[0,0,0] op_sel_hi:[1,0,1]
    v_pk_fma_f32 v[64:65], v[6:7], v[116:117], v[64:65] op_sel:[0,1,0] op_sel_hi:[1,1,1]
    v_lshlrev_b32 v6, 16, v249
    v_and_b32 v7, 0xffff0000, v249
    v_pk_fma_f32 v[58:59], v[6:7], v[116:117], v[58:59] op_sel:[0,0,0] op_sel_hi:[1,0,1]
    v_pk_fma_f32 v[66:67], v[6:7], v[116:117], v[66:67] op_sel:[0,1,0] op_sel_hi:[1,1,1]
    v_lshlrev_b32 v6, 16, v250
    v_and_b32 v7, 0xffff0000, v250
    v_pk_fma_f32 v[60:61], v[6:7], v[116:117], v[60:61] op_sel:[0,0,0] op_sel_hi:[1,0,1]
    v_pk_fma_f32 v[68:69], v[6:7], v[116:117], v[68:69] op_sel:[0,1,0] op_sel_hi:[1,1,1]
    v_lshlrev_b32 v6, 16, v251
    v_and_b32 v7, 0xffff0000, v251
    v_pk_fma_f32 v[62:63], v[6:7], v[116:117], v[62:63] op_sel:[0,0,0] op_sel_hi:[1,0,1]
    v_pk_fma_f32 v[70:71], v[6:7], v[116:117], v[70:71] op_sel:[0,1,0] op_sel_hi:[1,1,1]
    s_waitcnt lgkmcnt(0)
    v_lshlrev_b32 v6, 16, v252
    v_and_b32 v7, 0xffff0000, v252
    v_pk_fma_f32 v[56:57], v[6:7], v[118:119], v[56:57] op_sel:[0,0,0] op_sel_hi:[1,0,1]
    v_pk_fma_f32 v[64:65], v[6:7], v[118:119], v[64:65] op_sel:[0,1,0] op_sel_hi:[1,1,1]
    v_lshlrev_b32 v6, 16, v253
    v_and_b32 v7, 0xffff0000, v253
    v_pk_fma_f32 v[58:59], v[6:7], v[118:119], v[58:59] op_sel:[0,0,0] op_sel_hi:[1,0,1]
    v_pk_fma_f32 v[66:67], v[6:7], v[118:119], v[66:67] op_sel:[0,1,0] op_sel_hi:[1,1,1]
    v_lshlrev_b32 v6, 16, v254
    v_and_b32 v7, 0xffff0000, v254
    v_pk_fma_f32 v[60:61], v[6:7], v[118:119], v[60:61] op_sel:[0,0,0] op_sel_hi:[1,0,1]
    v_pk_fma_f32 v[68:69], v[6:7], v[118:119], v[68:69] op_sel:[0,1,0] op_sel_hi:[1,1,1]
    v_lshlrev_b32 v6, 16, v255
    v_and_b32 v7, 0xffff0000, v255
    v_pk_fma_f32 v[62:63], v[6:7], v[118:119], v[62:63] op_sel:[0,0,0] op_sel_hi:[1,0,1]
    v_pk_fma_f32 v[70:71], v[6:7], v[118:119], v[70:71] op_sel:[0,1,0] op_sel_hi:[1,1,1]
    s_mov_b32 s55, 29826162
    v_mul_hi_u32 v92, v0, s55
    v_mul_u32_u24 v93, 144, v92
    v_sub_u32 v93, v0, v93
    v_mul_u32_u24 v5, 1152, v92
    v_lshl_add_u32 v5, v93, 3, v5
    v_cmp_gt_u32 vcc, 0x1b0, v0
    v_mov_b32 v6, 0x7fffff00
    s_nop 1
    v_cndmask_b32 v5, v6, v5, vcc
    s_mul_i32 s55, s3, 36864
    buffer_load_dwordx2 v[16:17], v5, s[40:43], s55 offen nt
    s_add_u32 s55, s55, 3456
    buffer_load_dwordx2 v[18:19], v5, s[40:43], s55 offen nt
    s_add_u32 s55, s55, 3456
    buffer_load_dwordx2 v[20:21], v5, s[40:43], s55 offen nt
    s_add_u32 s55, s55, 3456
    buffer_load_dwordx2 v[22:23], v5, s[40:43], s55 offen nt
    s_add_u32 s55, s55, 3456
    buffer_load_dwordx2 v[24:25], v5, s[40:43], s55 offen nt
    s_add_u32 s55, s55, 3456
    buffer_load_dwordx2 v[26:27], v5, s[40:43], s55 offen nt
    s_add_u32 s55, s55, 3456
    buffer_load_dwordx2 v[28:29], v5, s[40:43], s55 offen nt
    s_add_u32 s55, s55, 3456
    buffer_load_dwordx2 v[30:31], v5, s[40:43], s55 offen nt
    s_add_u32 s55, s55, 3456
    buffer_load_dwordx2 v[32:33], v5, s[40:43], s55 offen nt
    s_add_u32 s55, s55, 3456
    buffer_load_dwordx2 v[34:35], v5, s[40:43], s55 offen nt
    s_add_u32 s55, s55, 3456
    buffer_load_dwordx2 v[36:37], v5, s[40:43], s55 offen nt
    s_add_u32 s55, s55, 3456
    v_lshrrev_b32 v5, 2, v0
    v_lshlrev_b32 v5, 13, v5
    v_and_b32 v6, 3, v0
    v_lshl_add_u32 v5, v6, 4, v5
    s_cmp_lt_u32 s2, 128
    s_cselect_b32 s55, 0x7fffff00, 0
    v_add_u32 v5, s55, v5
    s_lshl_b32 s55, s3, 6
    buffer_load_dwordx4 v[40:43], v5, s[44:47], s55 offen nt
    s_add_u32 s55, s55, 1048576
    buffer_load_dwordx4 v[44:47], v5, s[44:47], s55 offen nt
    s_add_u32 s55, s55, 1048576
    buffer_load_dwordx4 v[48:51], v5, s[44:47], s55 offen nt
    s_add_u32 s55, s55, 1048576
    buffer_load_dwordx4 v[52:55], v5, s[44:47], s55 offen nt
    s_add_u32 s55, s55, 1048576
    v_lshl_add_u32 v5, v1, 2, v3
    v_lshlrev_b32 v5, 10, v5
    v_lshl_add_u32 v5, v4, 5, v5
    ds_write_b128 v5, v[56:59] offset:17408
    ds_write_b128 v5, v[60:63] offset:17424
    ds_write_b128 v5, v[64:67] offset:17920
    ds_write_b128 v5, v[68:71] offset:17936
    s_waitcnt lgkmcnt(0)
    s_barrier
    s_cmp_ge_u32 s60, 4
    s_cbranch_scc1 ASK_10
    v_lshrrev_b32 v5, 7, v0
    v_and_b32 v6, 127, v0
    v_lshlrev_b32 v7, 2, v5
    ds_read_b32 v96, v7 offset:16384
    ds_read_b32 v104, v7 offset:16392
    ds_read_b32 v97, v7 offset:16400
    ds_read_b32 v105, v7 offset:16408
    ds_read_b32 v98, v7 offset:16416
    ds_read_b32 v106, v7 offset:16424
    ds_read_b32 v99, v7 offset:16432
    ds_read_b32 v107, v7 offset:16440
    ds_read_b32 v100, v7 offset:16448
    ds_read_b32 v108, v7 offset:16456
    ds_read_b32 v101, v7 offset:16464
    ds_read_b32 v109, v7 offset:16472
    ds_read_b32 v102, v7 offset:16480
    ds_read_b32 v110, v7 offset:16488
    ds_read_b32 v103, v7 offset:16496
    ds_read_b32 v111, v7 offset:16504
    v_lshlrev_b32 v8, 9, v5
    v_lshl_add_u32 v8, v6, 2, v8
    ds_read_b32 v112, v8 offset:17408
    ds_read_b32 v113, v8 offset:18432
    ds_read_b32 v114, v8 offset:19456
    ds_read_b32 v115, v8 offset:20480
    ds_read_b32 v116, v8 offset:21504
    ds_read_b32 v117, v8 offset:22528
    ds_read_b32 v118, v8 offset:23552
    ds_read_b32 v119, v8 offset:24576
    ds_read_b32 v120, v8 offset:25600
    ds_read_b32 v121, v8 offset:26624
    ds_read_b32 v122, v8 offset:27648
    ds_read_b32 v123, v8 offset:28672
    ds_read_b32 v124, v8 offset:29696
    ds_read_b32 v125, v8 offset:30720
    ds_read_b32 v126, v8 offset:31744
    ds_read_b32 v127, v8 offset:32768
    ds_read_b32 v128, v8 offset:33792
    ds_read_b32 v129, v8 offset:34816
    ds_read_b32 v130, v8 offset:35840
    ds_read_b32 v131, v8 offset:36864
    ds_read_b32 v132, v8 offset:37888
    ds_read_b32 v133, v8 offset:38912
    ds_read_b32 v134, v8 offset:39936
    ds_read_b32 v135, v8 offset:40960
    ds_read_b32 v136, v8 offset:41984
    ds_read_b32 v137, v8 offset:43008
    ds_read_b32 v138, v8 offset:44032
    ds_read_b32 v139, v8 offset:45056
    ds_read_b32 v140, v8 offset:46080
    ds_read_b32 v141, v8 offset:47104
    ds_read_b32 v142, v8 offset:48128
    ds_read_b32 v143, v8 offset:49152
    s_waitcnt lgkmcnt(0)
    v_max_f32 v9, v96, v97
    v_max_f32 v9, v9, v98
    v_max_f32 v9, v9, v99
    v_max_f32 v9, v9, v100
    v_max_f32 v9, v9, v101
    v_max_f32 v9, v9, v102
    v_max_f32 v9, v9, v103
    v_sub_f32 v96, v96, v9
    v_mul_f32 v96, s61, v96
    v_exp_f32 v96, v96
    v_sub_f32 v97, v97, v9
    v_mul_f32 v97, s61, v97
    v_exp_f32 v97, v97
    v_sub_f32 v98, v98, v9
    v_mul_f32 v98, s61, v98
    v_exp_f32 v98, v98
    v_sub_f32 v99, v99, v9
    v_mul_f32 v99, s61, v99
    v_exp_f32 v99, v99
    v_sub_f32 v100, v100, v9
    v_mul_f32 v100, s61, v100
    v_exp_f32 v100, v100
    v_sub_f32 v101, v101, v9
    v_mul_f32 v101, s61, v101
    v_exp_f32 v101, v101
    v_sub_f32 v102, v102, v9
    v_mul_f32 v102, s61, v102
    v_exp_f32 v102, v102
    v_sub_f32 v103, v103, v9
    v_mul_f32 v103, s61, v103
    v_exp_f32 v103, v103
    v_mov_b32 v10, 0
    v_mov_b32 v11, 0
    v_add_f32 v12, v112, v113
    v_add_f32 v13, v114, v115
    v_add_f32 v12, v12, v13
    v_fmac_f32 v10, v96, v12
    v_fmac_f32 v11, v96, v104
    v_add_f32 v12, v116, v117
    v_add_f32 v13, v118, v119
    v_add_f32 v12, v12, v13
    v_fmac_f32 v10, v97, v12
    v_fmac_f32 v11, v97, v105
    v_add_f32 v12, v120, v121
    v_add_f32 v13, v122, v123
    v_add_f32 v12, v12, v13
    v_fmac_f32 v10, v98, v12
    v_fmac_f32 v11, v98, v106
    v_add_f32 v12, v124, v125
    v_add_f32 v13, v126, v127
    v_add_f32 v12, v12, v13
    v_fmac_f32 v10, v99, v12
    v_fmac_f32 v11, v99, v107
    v_add_f32 v12, v128, v129
    v_add_f32 v13, v130, v131
    v_add_f32 v12, v12, v13
    v_fmac_f32 v10, v100, v12
    v_fmac_f32 v11, v100, v108
    v_add_f32 v12, v132, v133
    v_add_f32 v13, v134, v135
    v_add_f32 v12, v12, v13
    v_fmac_f32 v10, v101, v12
    v_fmac_f32 v11, v101, v109
    v_add_f32 v12, v136, v137
    v_add_f32 v13, v138, v139
    v_add_f32 v12, v12, v13
    v_fmac_f32 v10, v102, v12
    v_fmac_f32 v11, v102, v110
    v_add_f32 v12, v140, v141
    v_add_f32 v13, v142, v143
    v_add_f32 v12, v12, v13
    v_fmac_f32 v10, v103, v12
    v_fmac_f32 v11, v103, v111
    v_mul_f32 v9, s61, v9
    s_mul_i32 s55, s96, 12
    s_add_u32 s55, s55, s97
    s_mul_i32 s55, s55, 528
    s_add_u32 s55, s55, 98304
    v_mul_u32_u24 v12, 3168, v5
    v_lshl_add_u32 v12, v6, 2, v12
    buffer_store_dword v10, v12, s[32:35], s55 offen sc1
    v_cmp_eq_u32 vcc, 0, v6
    s_and_saveexec_b64 s[62:63], vcc
    s_cbranch_execz ASK2_11
    v_mov_b32 v10, v9
    buffer_store_dwordx2 v[10:11], v12, s[32:35], s55 offen offset:512 sc1
ASK2_11:
    s_mov_b64 exec, s[62:63]
ASK_10:
    s_waitcnt vmcnt(0)
    s_barrier
    s_cmp_lg_u32 s60, 0
    s_cbranch_scc1 W0E_12
    s_and_b32 s55, s96, 15
    s_lshl_b32 s55, s55, 2
    s_mov_b64 s[62:63], exec
    s_mov_b64 exec, 1
    v_mov_b32 v5, 1
    v_mov_b32 v6, s55
    v_lshlrev_b32 v6, 5, v6
    v_add_u32 v6, 7864320, v6
    buffer_atomic_add v5, v6, s[32:35], 0 offen
    s_mov_b64 exec, s[62:63]
W0E_12:
    s_branch P3
ATT_B:
    s_lshr_b32 s56, s96, 1
    s_and_b32 s57, s96, 1
    v_lshrrev_b32 v7, 4, v0
    v_lshlrev_b32 v9, 13, v7
    v_lshl_add_u32 v9, v4, 4, v9
    s_lshl_b32 s55, s56, 8
    buffer_load_dwordx4 v[64:67], v9, s[12:15], s55 offen nt
    s_add_u32 s55, s55, 262144
    buffer_load_dwordx4 v[68:71], v9, s[12:15], s55 offen nt
    s_add_u32 s55, s55, 262144
    buffer_load_dwordx4 v[72:75], v9, s[12:15], s55 offen nt
    s_add_u32 s55, s55, 262144
    buffer_load_dwordx4 v[76:79], v9, s[12:15], s55 offen nt
    s_add_u32 s55, s55, 262144
    buffer_load_dwordx4 v[80:83], v9, s[12:15], s55 offen nt
    s_add_u32 s55, s55, 262144
    buffer_load_dwordx4 v[84:87], v9, s[12:15], s55 offen nt
    s_add_u32 s55, s55, 262144
    buffer_load_dwordx4 v[88:91], v9, s[12:15], s55 offen nt
    s_add_u32 s55, s55, 262144
    buffer_load_dwordx4 v[92:95], v9, s[12:15], s55 offen nt
    s_add_u32 s55, s55, 262144
    buffer_load_dwordx4 v[96:99], v9, s[12:15], s55 offen nt
    s_add_u32 s55, s55, 262144
    buffer_load_dwordx4 v[100:103], v9, s[12:15], s55 offen nt
    s_add_u32 s55, s55, 262144
    buffer_load_dwordx4 v[104:107], v9, s[12:15], s55 offen nt
    s_add_u32 s55, s55, 262144
    buffer_load_dwordx4 v[108:111], v9, s[12:15], s55 offen nt
    s_add_u32 s55, s55, 262144
    buffer_load_dwordx4 v[112:115], v9, s[12:15], s55 offen nt
    s_add_u32 s55, s55, 262144
    buffer_load_dwordx4 v[116:119], v9, s[12:15], s55 offen nt
    s_add_u32 s55, s55, 262144
    buffer_load_dwordx4 v[120:123], v9, s[12:15], s55 offen nt
    s_add_u32 s55, s55, 262144
    buffer_load_dwordx4 v[124:127], v9, s[12:15], s55 offen nt
    s_add_u32 s55, s55, 262144
    buffer_load_dwordx4 v[128:131], v9, s[12:15], s55 offen nt
    s_add_u32 s55, s55, 262144
    buffer_load_dwordx4 v[132:135], v9, s[12:15], s55 offen nt
    s_add_u32 s55, s55, 262144
    v_lshlrev_b32 v10, 1, v7
    buffer_load_ushort v136, v10, s[8:11], 0 offen offset:0
    buffer_load_ushort v137, v10, s[8:11], 0 offen offset:1152
    buffer_load_ushort v138, v10, s[8:11], 0 offen offset:64
    buffer_load_ushort v139, v10, s[8:11], 0 offen offset:1216
    buffer_load_ushort v140, v10, s[8:11], 0 offen offset:128
    buffer_load_ushort v141, v10, s[8:11], 0 offen offset:1280
    buffer_load_ushort v142, v10, s[8:11], 0 offen offset:192
    buffer_load_ushort v143, v10, s[8:11], 0 offen offset:1344
    buffer_load_ushort v144, v10, s[8:11], 0 offen offset:256
    buffer_load_ushort v145, v10, s[8:11], 0 offen offset:1408
    buffer_load_ushort v146, v10, s[8:11], 0 offen offset:320
    buffer_load_ushort v147, v10, s[8:11], 0 offen offset:1472
    buffer_load_ushort v148, v10, s[8:11], 0 offen offset:384
    buffer_load_ushort v149, v10, s[8:11], 0 offen offset:1536
    buffer_load_ushort v150, v10, s[8:11], 0 offen offset:448
    buffer_load_ushort v151, v10, s[8:11], 0 offen offset:1600
    buffer_load_ushort v152, v10, s[8:11], 0 offen offset:512
    buffer_load_ushort v153, v10, s[8:11], 0 offen offset:1664
    buffer_load_ushort v154, v10, s[8:11], 0 offen offset:576
    buffer_load_ushort v155, v10, s[8:11], 0 offen offset:1728
    buffer_load_ushort v156, v10, s[8:11], 0 offen offset:640
    buffer_load_ushort v157, v10, s[8:11], 0 offen offset:1792
    buffer_load_ushort v158, v10, s[8:11], 0 offen offset:704
    buffer_load_ushort v159, v10, s[8:11], 0 offen offset:1856
    buffer_load_ushort v160, v10, s[8:11], 0 offen offset:768
    buffer_load_ushort v161, v10, s[8:11], 0 offen offset:1920
    buffer_load_ushort v162, v10, s[8:11], 0 offen offset:832
    buffer_load_ushort v163, v10, s[8:11], 0 offen offset:1984
    buffer_load_ushort v164, v10, s[8:11], 0 offen offset:896
    buffer_load_ushort v165, v10, s[8:11], 0 offen offset:2048
    buffer_load_ushort v166, v10, s[8:11], 0 offen offset:960
    buffer_load_ushort v167, v10, s[8:11], 0 offen offset:2112
    buffer_load_ushort v168, v10, s[8:11], 0 offen offset:1024
    buffer_load_ushort v169, v10, s[8:11], 0 offen offset:2176
    buffer_load_ushort v170, v10, s[8:11], 0 offen offset:1088
    buffer_load_ushort v171, v10, s[8:11], 0 offen offset:2240
    s_lshl_b32 s55, s57, 21
    s_lshl_b32 s58, s56, 8
    s_add_u32 s55, s55, s58
    buffer_load_dwordx4 v[172:175], v9, s[16:19], s55 offen nt
    s_add_u32 s55, s55, 262144
    buffer_load_dwordx4 v[176:179], v9, s[16:19], s55 offen nt
    s_add_u32 s55, s55, 262144
    buffer_load_dwordx4 v[180:183], v9, s[16:19], s55 offen nt
    s_add_u32 s55, s55, 262144
    buffer_load_dwordx4 v[184:187], v9, s[16:19], s55 offen nt
    s_add_u32 s55, s55, 262144
    buffer_load_dwordx4 v[188:191], v9, s[16:19], s55 offen nt
    s_add_u32 s55, s55, 262144
    buffer_load_dwordx4 v[192:195], v9, s[16:19], s55 offen nt
    s_add_u32 s55, s55, 262144
    buffer_load_dwordx4 v[196:199], v9, s[16:19], s55 offen nt
    s_add_u32 s55, s55, 262144
    buffer_load_dwordx4 v[200:203], v9, s[16:19], s55 offen nt
    s_add_u32 s55, s55, 262144
    v_mov_b32 v16, 0
    v_mov_b32 v17, 0
    v_mov_b32 v18, 0
    v_mov_b32 v19, 0
    v_mov_b32 v20, 0
    v_mov_b32 v21, 0
    v_mov_b32 v22, 0
    v_mov_b32 v23, 0
    v_mov_b32 v24, 0
    v_mov_b32 v25, 0
    v_mov_b32 v26, 0
    v_mov_b32 v27, 0
    v_mov_b32 v28, 0
    v_mov_b32 v29, 0
    v_mov_b32 v30, 0
    v_mov_b32 v31, 0
    s_waitcnt vmcnt(8)
    v_lshlrev_b32 v136, 16, v136
    v_lshlrev_b32 v137, 16, v137
    v_lshlrev_b32 v138, 16, v138
    v_lshlrev_b32 v139, 16, v139
    v_lshlrev_b32 v140, 16, v140
    v_lshlrev_b32 v141, 16, v141
    v_lshlrev_b32 v142, 16, v142
    v_lshlrev_b32 v143, 16, v143
    v_lshlrev_b32 v144, 16, v144
    v_lshlrev_b32 v145, 16, v145
    v_lshlrev_b32 v146, 16, v146
    v_lshlrev_b32 v147, 16, v147
    v_lshlrev_b32 v148, 16, v148
    v_lshlrev_b32 v149, 16, v149
    v_lshlrev_b32 v150, 16, v150
    v_lshlrev_b32 v151, 16, v151
    v_lshlrev_b32 v152, 16, v152
    v_lshlrev_b32 v153, 16, v153
    v_lshlrev_b32 v154, 16, v154
    v_lshlrev_b32 v155, 16, v155
    v_lshlrev_b32 v156, 16, v156
    v_lshlrev_b32 v157, 16, v157
    v_lshlrev_b32 v158, 16, v158
    v_lshlrev_b32 v159, 16, v159
    v_lshlrev_b32 v160, 16, v160
    v_lshlrev_b32 v161, 16, v161
    v_lshlrev_b32 v162, 16, v162
    v_lshlrev_b32 v163, 16, v163
    v_lshlrev_b32 v164, 16, v164
    v_lshlrev_b32 v165, 16, v165
    v_lshlrev_b32 v166, 16, v166
    v_lshlrev_b32 v167, 16, v167
    v_lshlrev_b32 v168, 16, v168
    v_lshlrev_b32 v169, 16, v169
    v_lshlrev_b32 v170, 16, v170
    v_lshlrev_b32 v171, 16, v171
    v_lshlrev_b32 v32, 16, v64
    v_and_b32 v33, 0xffff0000, v64
    v_fmac_f32 v16, v136, v32
    v_fmac_f32 v17, v136, v33
    v_fmac_f32 v24, v137, v32
    v_fmac_f32 v25, v137, v33
    v_lshlrev_b32 v32, 16, v65
    v_and_b32 v33, 0xffff0000, v65
    v_fmac_f32 v18, v136, v32
    v_fmac_f32 v19, v136, v33
    v_fmac_f32 v26, v137, v32
    v_fmac_f32 v27, v137, v33
    v_lshlrev_b32 v32, 16, v66
    v_and_b32 v33, 0xffff0000, v66
    v_fmac_f32 v20, v136, v32
    v_fmac_f32 v21, v136, v33
    v_fmac_f32 v28, v137, v32
    v_fmac_f32 v29, v137, v33
    v_lshlrev_b32 v32, 16, v67
    v_and_b32 v33, 0xffff0000, v67
    v_fmac_f32 v22, v136, v32
    v_fmac_f32 v23, v136, v33
    v_fmac_f32 v30, v137, v32
    v_fmac_f32 v31, v137, v33
    v_lshlrev_b32 v32, 16, v68
    v_and_b32 v33, 0xffff0000, v68
    v_fmac_f32 v16, v138, v32
    v_fmac_f32 v17, v138, v33
    v_fmac_f32 v24, v139, v32
    v_fmac_f32 v25, v139, v33
    v_lshlrev_b32 v32, 16, v69
    v_and_b32 v33, 0xffff0000, v69
    v_fmac_f32 v18, v138, v32
    v_fmac_f32 v19, v138, v33
    v_fmac_f32 v26, v139, v32
    v_fmac_f32 v27, v139, v33
    v_lshlrev_b32 v32, 16, v70
    v_and_b32 v33, 0xffff0000, v70
    v_fmac_f32 v20, v138, v32
    v_fmac_f32 v21, v138, v33
    v_fmac_f32 v28, v139, v32
    v_fmac_f32 v29, v139, v33
    v_lshlrev_b32 v32, 16, v71
    v_and_b32 v33, 0xffff0000, v71
    v_fmac_f32 v22, v138, v32
    v_fmac_f32 v23, v138, v33
    v_fmac_f32 v30, v139, v32
    v_fmac_f32 v31, v139, v33
    v_lshlrev_b32 v32, 16, v72
    v_and_b32 v33, 0xffff0000, v72
    v_fmac_f32 v16, v140, v32
    v_fmac_f32 v17, v140, v33
    v_fmac_f32 v24, v141, v32
    v_fmac_f32 v25, v141, v33
    v_lshlrev_b32 v32, 16, v73
    v_and_b32 v33, 0xffff0000, v73
    v_fmac_f32 v18, v140, v32
    v_fmac_f32 v19, v140, v33
    v_fmac_f32 v26, v141, v32
    v_fmac_f32 v27, v141, v33
    v_lshlrev_b32 v32, 16, v74
    v_and_b32 v33, 0xffff0000, v74
    v_fmac_f32 v20, v140, v32
    v_fmac_f32 v21, v140, v33
    v_fmac_f32 v28, v141, v32
    v_fmac_f32 v29, v141, v33
    v_lshlrev_b32 v32, 16, v75
    v_and_b32 v33, 0xffff0000, v75
    v_fmac_f32 v22, v140, v32
    v_fmac_f32 v23, v140, v33
    v_fmac_f32 v30, v141, v32
    v_fmac_f32 v31, v141, v33
    v_lshlrev_b32 v32, 16, v76
    v_and_b32 v33, 0xffff0000, v76
    v_fmac_f32 v16, v142, v32
    v_fmac_f32 v17, v142, v33
    v_fmac_f32 v24, v143, v32
    v_fmac_f32 v25, v143, v33
    v_lshlrev_b32 v32, 16, v77
    v_and_b32 v33, 0xffff0000, v77
    v_fmac_f32 v18, v142, v32
    v_fmac_f32 v19, v142, v33
    v_fmac_f32 v26, v143, v32
    v_fmac_f32 v27, v143, v33
    v_lshlrev_b32 v32, 16, v78
    v_and_b32 v33, 0xffff0000, v78
    v_fmac_f32 v20, v142, v32
    v_fmac_f32 v21, v142, v33
    v_fmac_f32 v28, v143, v32
    v_fmac_f32 v29, v143, v33
    v_lshlrev_b32 v32, 16, v79
    v_and_b32 v33, 0xffff0000, v79
    v_fmac_f32 v22, v142, v32
    v_fmac_f32 v23, v142, v33
    v_fmac_f32 v30, v143, v32
    v_fmac_f32 v31, v143, v33
    v_lshlrev_b32 v32, 16, v80
    v_and_b32 v33, 0xffff0000, v80
    v_fmac_f32 v16, v144, v32
    v_fmac_f32 v17, v144, v33
    v_fmac_f32 v24, v145, v32
    v_fmac_f32 v25, v145, v33
    v_lshlrev_b32 v32, 16, v81
    v_and_b32 v33, 0xffff0000, v81
    v_fmac_f32 v18, v144, v32
    v_fmac_f32 v19, v144, v33
    v_fmac_f32 v26, v145, v32
    v_fmac_f32 v27, v145, v33
    v_lshlrev_b32 v32, 16, v82
    v_and_b32 v33, 0xffff0000, v82
    v_fmac_f32 v20, v144, v32
    v_fmac_f32 v21, v144, v33
    v_fmac_f32 v28, v145, v32
    v_fmac_f32 v29, v145, v33
    v_lshlrev_b32 v32, 16, v83
    v_and_b32 v33, 0xffff0000, v83
    v_fmac_f32 v22, v144, v32
    v_fmac_f32 v23, v144, v33
    v_fmac_f32 v30, v145, v32
    v_fmac_f32 v31, v145, v33
    v_lshlrev_b32 v32, 16, v84
    v_and_b32 v33, 0xffff0000, v84
    v_fmac_f32 v16, v146, v32
    v_fmac_f32 v17, v146, v33
    v_fmac_f32 v24, v147, v32
    v_fmac_f32 v25, v147, v33
    v_lshlrev_b32 v32, 16, v85
    v_and_b32 v33, 0xffff0000, v85
    v_fmac_f32 v18, v146, v32
    v_fmac_f32 v19, v146, v33
    v_fmac_f32 v26, v147, v32
    v_fmac_f32 v27, v147, v33
    v_lshlrev_b32 v32, 16, v86
    v_and_b32 v33, 0xffff0000, v86
    v_fmac_f32 v20, v146, v32
    v_fmac_f32 v21, v146, v33
    v_fmac_f32 v28, v147, v32
    v_fmac_f32 v29, v147, v33
    v_lshlrev_b32 v32, 16, v87
    v_and_b32 v33, 0xffff0000, v87
    v_fmac_f32 v22, v146, v32
    v_fmac_f32 v23, v146, v33
    v_fmac_f32 v30, v147, v32
    v_fmac_f32 v31, v147, v33
    v_lshlrev_b32 v32, 16, v88
    v_and_b32 v33, 0xffff0000, v88
    v_fmac_f32 v16, v148, v32
    v_fmac_f32 v17, v148, v33
    v_fmac_f32 v24, v149, v32
    v_fmac_f32 v25, v149, v33
    v_lshlrev_b32 v32, 16, v89
    v_and_b32 v33, 0xffff0000, v89
    v_fmac_f32 v18, v148, v32
    v_fmac_f32 v19, v148, v33
    v_fmac_f32 v26, v149, v32
    v_fmac_f32 v27, v149, v33
    v_lshlrev_b32 v32, 16, v90
    v_and_b32 v33, 0xffff0000, v90
    v_fmac_f32 v20, v148, v32
    v_fmac_f32 v21, v148, v33
    v_fmac_f32 v28, v149, v32
    v_fmac_f32 v29, v149, v33
    v_lshlrev_b32 v32, 16, v91
    v_and_b32 v33, 0xffff0000, v91
    v_fmac_f32 v22, v148, v32
    v_fmac_f32 v23, v148, v33
    v_fmac_f32 v30, v149, v32
    v_fmac_f32 v31, v149, v33
    v_lshlrev_b32 v32, 16, v92
    v_and_b32 v33, 0xffff0000, v92
    v_fmac_f32 v16, v150, v32
    v_fmac_f32 v17, v150, v33
    v_fmac_f32 v24, v151, v32
    v_fmac_f32 v25, v151, v33
    v_lshlrev_b32 v32, 16, v93
    v_and_b32 v33, 0xffff0000, v93
    v_fmac_f32 v18, v150, v32
    v_fmac_f32 v19, v150, v33
    v_fmac_f32 v26, v151, v32
    v_fmac_f32 v27, v151, v33
    v_lshlrev_b32 v32, 16, v94
    v_and_b32 v33, 0xffff0000, v94
    v_fmac_f32 v20, v150, v32
    v_fmac_f32 v21, v150, v33
    v_fmac_f32 v28, v151, v32
    v_fmac_f32 v29, v151, v33
    v_lshlrev_b32 v32, 16, v95
    v_and_b32 v33, 0xffff0000, v95
    v_fmac_f32 v22, v150, v32
    v_fmac_f32 v23, v150, v33
    v_fmac_f32 v30, v151, v32
    v_fmac_f32 v31, v151, v33
    v_lshlrev_b32 v32, 16, v96
    v_and_b32 v33, 0xffff0000, v96
    v_fmac_f32 v16, v152, v32
    v_fmac_f32 v17, v152, v33
    v_fmac_f32 v24, v153, v32
    v_fmac_f32 v25, v153, v33
    v_lshlrev_b32 v32, 16, v97
    v_and_b32 v33, 0xffff0000, v97
    v_fmac_f32 v18, v152, v32
    v_fmac_f32 v19, v152, v33
    v_fmac_f32 v26, v153, v32
    v_fmac_f32 v27, v153, v33
    v_lshlrev_b32 v32, 16, v98
    v_and_b32 v33, 0xffff0000, v98
    v_fmac_f32 v20, v152, v32
    v_fmac_f32 v21, v152, v33
    v_fmac_f32 v28, v153, v32
    v_fmac_f32 v29, v153, v33
    v_lshlrev_b32 v32, 16, v99
    v_and_b32 v33, 0xffff0000, v99
    v_fmac_f32 v22, v152, v32
    v_fmac_f32 v23, v152, v33
    v_fmac_f32 v30, v153, v32
    v_fmac_f32 v31, v153, v33
    v_lshlrev_b32 v32, 16, v100
    v_and_b32 v33, 0xffff0000, v100
    v_fmac_f32 v16, v154, v32
    v_fmac_f32 v17, v154, v33
    v_fmac_f32 v24, v155, v32
    v_fmac_f32 v25, v155, v33
    v_lshlrev_b32 v32, 16, v101
    v_and_b32 v33, 0xffff0000, v101
    v_fmac_f32 v18, v154, v32
    v_fmac_f32 v19, v154, v33
    v_fmac_f32 v26, v155, v32
    v_fmac_f32 v27, v155, v33
    v_lshlrev_b32 v32, 16, v102
    v_and_b32 v33, 0xffff0000, v102
    v_fmac_f32 v20, v154, v32
    v_fmac_f32 v21, v154, v33
    v_fmac_f32 v28, v155, v32
    v_fmac_f32 v29, v155, v33
    v_lshlrev_b32 v32, 16, v103
    v_and_b32 v33, 0xffff0000, v103
    v_fmac_f32 v22, v154, v32
    v_fmac_f32 v23, v154, v33
    v_fmac_f32 v30, v155, v32
    v_fmac_f32 v31, v155, v33
    v_lshlrev_b32 v32, 16, v104
    v_and_b32 v33, 0xffff0000, v104
    v_fmac_f32 v16, v156, v32
    v_fmac_f32 v17, v156, v33
    v_fmac_f32 v24, v157, v32
    v_fmac_f32 v25, v157, v33
    v_lshlrev_b32 v32, 16, v105
    v_and_b32 v33, 0xffff0000, v105
    v_fmac_f32 v18, v156, v32
    v_fmac_f32 v19, v156, v33
    v_fmac_f32 v26, v157, v32
    v_fmac_f32 v27, v157, v33
    v_lshlrev_b32 v32, 16, v106
    v_and_b32 v33, 0xffff0000, v106
    v_fmac_f32 v20, v156, v32
    v_fmac_f32 v21, v156, v33
    v_fmac_f32 v28, v157, v32
    v_fmac_f32 v29, v157, v33
    v_lshlrev_b32 v32, 16, v107
    v_and_b32 v33, 0xffff0000, v107
    v_fmac_f32 v22, v156, v32
    v_fmac_f32 v23, v156, v33
    v_fmac_f32 v30, v157, v32
    v_fmac_f32 v31, v157, v33
    v_lshlrev_b32 v32, 16, v108
    v_and_b32 v33, 0xffff0000, v108
    v_fmac_f32 v16, v158, v32
    v_fmac_f32 v17, v158, v33
    v_fmac_f32 v24, v159, v32
    v_fmac_f32 v25, v159, v33
    v_lshlrev_b32 v32, 16, v109
    v_and_b32 v33, 0xffff0000, v109
    v_fmac_f32 v18, v158, v32
    v_fmac_f32 v19, v158, v33
    v_fmac_f32 v26, v159, v32
    v_fmac_f32 v27, v159, v33
    v_lshlrev_b32 v32, 16, v110
    v_and_b32 v33, 0xffff0000, v110
    v_fmac_f32 v20, v158, v32
    v_fmac_f32 v21, v158, v33
    v_fmac_f32 v28, v159, v32
    v_fmac_f32 v29, v159, v33
    v_lshlrev_b32 v32, 16, v111
    v_and_b32 v33, 0xffff0000, v111
    v_fmac_f32 v22, v158, v32
    v_fmac_f32 v23, v158, v33
    v_fmac_f32 v30, v159, v32
    v_fmac_f32 v31, v159, v33
    v_lshlrev_b32 v32, 16, v112
    v_and_b32 v33, 0xffff0000, v112
    v_fmac_f32 v16, v160, v32
    v_fmac_f32 v17, v160, v33
    v_fmac_f32 v24, v161, v32
    v_fmac_f32 v25, v161, v33
    v_lshlrev_b32 v32, 16, v113
    v_and_b32 v33, 0xffff0000, v113
    v_fmac_f32 v18, v160, v32
    v_fmac_f32 v19, v160, v33
    v_fmac_f32 v26, v161, v32
    v_fmac_f32 v27, v161, v33
    v_lshlrev_b32 v32, 16, v114
    v_and_b32 v33, 0xffff0000, v114
    v_fmac_f32 v20, v160, v32
    v_fmac_f32 v21, v160, v33
    v_fmac_f32 v28, v161, v32
    v_fmac_f32 v29, v161, v33
    v_lshlrev_b32 v32, 16, v115
    v_and_b32 v33, 0xffff0000, v115
    v_fmac_f32 v22, v160, v32
    v_fmac_f32 v23, v160, v33
    v_fmac_f32 v30, v161, v32
    v_fmac_f32 v31, v161, v33
    v_lshlrev_b32 v32, 16, v116
    v_and_b32 v33, 0xffff0000, v116
    v_fmac_f32 v16, v162, v32
    v_fmac_f32 v17, v162, v33
    v_fmac_f32 v24, v163, v32
    v_fmac_f32 v25, v163, v33
    v_lshlrev_b32 v32, 16, v117
    v_and_b32 v33, 0xffff0000, v117
    v_fmac_f32 v18, v162, v32
    v_fmac_f32 v19, v162, v33
    v_fmac_f32 v26, v163, v32
    v_fmac_f32 v27, v163, v33
    v_lshlrev_b32 v32, 16, v118
    v_and_b32 v33, 0xffff0000, v118
    v_fmac_f32 v20, v162, v32
    v_fmac_f32 v21, v162, v33
    v_fmac_f32 v28, v163, v32
    v_fmac_f32 v29, v163, v33
    v_lshlrev_b32 v32, 16, v119
    v_and_b32 v33, 0xffff0000, v119
    v_fmac_f32 v22, v162, v32
    v_fmac_f32 v23, v162, v33
    v_fmac_f32 v30, v163, v32
    v_fmac_f32 v31, v163, v33
    v_lshlrev_b32 v32, 16, v120
    v_and_b32 v33, 0xffff0000, v120
    v_fmac_f32 v16, v164, v32
    v_fmac_f32 v17, v164, v33
    v_fmac_f32 v24, v165, v32
    v_fmac_f32 v25, v165, v33
    v_lshlrev_b32 v32, 16, v121
    v_and_b32 v33, 0xffff0000, v121
    v_fmac_f32 v18, v164, v32
    v_fmac_f32 v19, v164, v33
    v_fmac_f32 v26, v165, v32
    v_fmac_f32 v27, v165, v33
    v_lshlrev_b32 v32, 16, v122
    v_and_b32 v33, 0xffff0000, v122
    v_fmac_f32 v20, v164, v32
    v_fmac_f32 v21, v164, v33
    v_fmac_f32 v28, v165, v32
    v_fmac_f32 v29, v165, v33
    v_lshlrev_b32 v32, 16, v123
    v_and_b32 v33, 0xffff0000, v123
    v_fmac_f32 v22, v164, v32
    v_fmac_f32 v23, v164, v33
    v_fmac_f32 v30, v165, v32
    v_fmac_f32 v31, v165, v33
    v_lshlrev_b32 v32, 16, v124
    v_and_b32 v33, 0xffff0000, v124
    v_fmac_f32 v16, v166, v32
    v_fmac_f32 v17, v166, v33
    v_fmac_f32 v24, v167, v32
    v_fmac_f32 v25, v167, v33
    v_lshlrev_b32 v32, 16, v125
    v_and_b32 v33, 0xffff0000, v125
    v_fmac_f32 v18, v166, v32
    v_fmac_f32 v19, v166, v33
    v_fmac_f32 v26, v167, v32
    v_fmac_f32 v27, v167, v33
    v_lshlrev_b32 v32, 16, v126
    v_and_b32 v33, 0xffff0000, v126
    v_fmac_f32 v20, v166, v32
    v_fmac_f32 v21, v166, v33
    v_fmac_f32 v28, v167, v32
    v_fmac_f32 v29, v167, v33
    v_lshlrev_b32 v32, 16, v127
    v_and_b32 v33, 0xffff0000, v127
    v_fmac_f32 v22, v166, v32
    v_fmac_f32 v23, v166, v33
    v_fmac_f32 v30, v167, v32
    v_fmac_f32 v31, v167, v33
    v_lshlrev_b32 v32, 16, v128
    v_and_b32 v33, 0xffff0000, v128
    v_fmac_f32 v16, v168, v32
    v_fmac_f32 v17, v168, v33
    v_fmac_f32 v24, v169, v32
    v_fmac_f32 v25, v169, v33
    v_lshlrev_b32 v32, 16, v129
    v_and_b32 v33, 0xffff0000, v129
    v_fmac_f32 v18, v168, v32
    v_fmac_f32 v19, v168, v33
    v_fmac_f32 v26, v169, v32
    v_fmac_f32 v27, v169, v33
    v_lshlrev_b32 v32, 16, v130
    v_and_b32 v33, 0xffff0000, v130
    v_fmac_f32 v20, v168, v32
    v_fmac_f32 v21, v168, v33
    v_fmac_f32 v28, v169, v32
    v_fmac_f32 v29, v169, v33
    v_lshlrev_b32 v32, 16, v131
    v_and_b32 v33, 0xffff0000, v131
    v_fmac_f32 v22, v168, v32
    v_fmac_f32 v23, v168, v33
    v_fmac_f32 v30, v169, v32
    v_fmac_f32 v31, v169, v33
    v_lshlrev_b32 v32, 16, v132
    v_and_b32 v33, 0xffff0000, v132
    v_fmac_f32 v16, v170, v32
    v_fmac_f32 v17, v170, v33
    v_fmac_f32 v24, v171, v32
    v_fmac_f32 v25, v171, v33
    v_lshlrev_b32 v32, 16, v133
    v_and_b32 v33, 0xffff0000, v133
    v_fmac_f32 v18, v170, v32
    v_fmac_f32 v19, v170, v33
    v_fmac_f32 v26, v171, v32
    v_fmac_f32 v27, v171, v33
    v_lshlrev_b32 v32, 16, v134
    v_and_b32 v33, 0xffff0000, v134
    v_fmac_f32 v20, v170, v32
    v_fmac_f32 v21, v170, v33
    v_fmac_f32 v28, v171, v32
    v_fmac_f32 v29, v171, v33
    v_lshlrev_b32 v32, 16, v135
    v_and_b32 v33, 0xffff0000, v135
    v_fmac_f32 v22, v170, v32
    v_fmac_f32 v23, v170, v33
    v_fmac_f32 v30, v171, v32
    v_fmac_f32 v31, v171, v33
    v_lshlrev_b32 v5, 10, v7
    v_lshl_add_u32 v5, v4, 5, v5
    ds_write_b128 v5, v[16:19] offset:0
    ds_write_b128 v5, v[20:23] offset:16
    ds_write_b128 v5, v[24:27] offset:512
    ds_write_b128 v5, v[28:31] offset:528
    s_waitcnt lgkmcnt(0)
    s_barrier
    s_cmp_ge_u32 s60, 4
    s_cbranch_scc1 BPK_13
    v_lshlrev_b32 v5, 2, v0
    ds_read_b32 v64, v5 offset:0
    ds_read_b32 v65, v5 offset:1024
    ds_read_b32 v66, v5 offset:2048
    ds_read_b32 v67, v5 offset:3072
    ds_read_b32 v68, v5 offset:4096
    ds_read_b32 v69, v5 offset:5120
    ds_read_b32 v70, v5 offset:6144
    ds_read_b32 v71, v5 offset:7168
    ds_read_b32 v72, v5 offset:8192
    ds_read_b32 v73, v5 offset:9216
    ds_read_b32 v74, v5 offset:10240
    ds_read_b32 v75, v5 offset:11264
    ds_read_b32 v76, v5 offset:12288
    ds_read_b32 v77, v5 offset:13312
    ds_read_b32 v78, v5 offset:14336
    ds_read_b32 v79, v5 offset:15360
    ds_read_b32 v80, v5 offset:16384
    ds_read_b32 v81, v5 offset:17408
    ds_read_b32 v82, v5 offset:18432
    ds_read_b32 v83, v5 offset:19456
    ds_read_b32 v84, v5 offset:20480
    ds_read_b32 v85, v5 offset:21504
    ds_read_b32 v86, v5 offset:22528
    ds_read_b32 v87, v5 offset:23552
    ds_read_b32 v88, v5 offset:24576
    ds_read_b32 v89, v5 offset:25600
    ds_read_b32 v90, v5 offset:26624
    ds_read_b32 v91, v5 offset:27648
    ds_read_b32 v92, v5 offset:28672
    ds_read_b32 v93, v5 offset:29696
    ds_read_b32 v94, v5 offset:30720
    ds_read_b32 v95, v5 offset:31744
    s_waitcnt lgkmcnt(0)
    v_add_f32 v64, v64, v65
    v_add_f32 v64, v64, v66
    v_add_f32 v64, v64, v67
    v_add_f32 v64, v64, v68
    v_add_f32 v64, v64, v69
    v_add_f32 v64, v64, v70
    v_add_f32 v64, v64, v71
    v_add_f32 v64, v64, v72
    v_add_f32 v64, v64, v73
    v_add_f32 v64, v64, v74
    v_add_f32 v64, v64, v75
    v_add_f32 v64, v64, v76
    v_add_f32 v64, v64, v77
    v_add_f32 v64, v64, v78
    v_add_f32 v64, v64, v79
    v_add_f32 v64, v64, v80
    v_add_f32 v64, v64, v81
    v_add_f32 v64, v64, v82
    v_add_f32 v64, v64, v83
    v_add_f32 v64, v64, v84
    v_add_f32 v64, v64, v85
    v_add_f32 v64, v64, v86
    v_add_f32 v64, v64, v87
    v_add_f32 v64, v64, v88
    v_add_f32 v64, v64, v89
    v_add_f32 v64, v64, v90
    v_add_f32 v64, v64, v91
    v_add_f32 v64, v64, v92
    v_add_f32 v64, v64, v93
    v_add_f32 v64, v64, v94
    v_add_f32 v64, v64, v95
    v_cvt_pk_bf16_f32 v64, v64, v64
    v_lshlrev_b32 v5, 1, v0
    ds_write_b16 v5, v64 offset:32768
    s_waitcnt lgkmcnt(0)
BPK_13:
    s_barrier
    v_lshlrev_b32 v5, 4, v4
    ds_read_b128 v[32:35], v5 offset:32768
    ds_read_b128 v[36:39], v5 offset:33024
    v_mov_b32 v16, 0
    v_mov_b32 v17, 0
    v_mov_b32 v18, 0
    v_mov_b32 v19, 0
    v_mov_b32 v20, 0
    v_mov_b32 v21, 0
    v_mov_b32 v22, 0
    v_mov_b32 v23, 0
    v_mov_b32 v24, 0
    v_mov_b32 v25, 0
    v_mov_b32 v26, 0
    v_mov_b32 v27, 0
    v_mov_b32 v28, 0
    v_mov_b32 v29, 0
    v_mov_b32 v30, 0
    v_mov_b32 v31, 0
    s_waitcnt vmcnt(0) lgkmcnt(0)
    v_dot2_f32_bf16 v16, v172, v32, v16
    v_dot2_f32_bf16 v17, v172, v36, v17
    v_dot2_f32_bf16 v18, v176, v32, v18
    v_dot2_f32_bf16 v19, v176, v36, v19
    v_dot2_f32_bf16 v20, v180, v32, v20
    v_dot2_f32_bf16 v21, v180, v36, v21
    v_dot2_f32_bf16 v22, v184, v32, v22
    v_dot2_f32_bf16 v23, v184, v36, v23
    v_dot2_f32_bf16 v24, v188, v32, v24
    v_dot2_f32_bf16 v25, v188, v36, v25
    v_dot2_f32_bf16 v26, v192, v32, v26
    v_dot2_f32_bf16 v27, v192, v36, v27
    v_dot2_f32_bf16 v28, v196, v32, v28
    v_dot2_f32_bf16 v29, v196, v36, v29
    v_dot2_f32_bf16 v30, v200, v32, v30
    v_dot2_f32_bf16 v31, v200, v36, v31
    v_dot2_f32_bf16 v16, v173, v33, v16
    v_dot2_f32_bf16 v17, v173, v37, v17
    v_dot2_f32_bf16 v18, v177, v33, v18
    v_dot2_f32_bf16 v19, v177, v37, v19
    v_dot2_f32_bf16 v20, v181, v33, v20
    v_dot2_f32_bf16 v21, v181, v37, v21
    v_dot2_f32_bf16 v22, v185, v33, v22
    v_dot2_f32_bf16 v23, v185, v37, v23
    v_dot2_f32_bf16 v24, v189, v33, v24
    v_dot2_f32_bf16 v25, v189, v37, v25
    v_dot2_f32_bf16 v26, v193, v33, v26
    v_dot2_f32_bf16 v27, v193, v37, v27
    v_dot2_f32_bf16 v28, v197, v33, v28
    v_dot2_f32_bf16 v29, v197, v37, v29
    v_dot2_f32_bf16 v30, v201, v33, v30
    v_dot2_f32_bf16 v31, v201, v37, v31
    v_dot2_f32_bf16 v16, v174, v34, v16
    v_dot2_f32_bf16 v17, v174, v38, v17
    v_dot2_f32_bf16 v18, v178, v34, v18
    v_dot2_f32_bf16 v19, v178, v38, v19
    v_dot2_f32_bf16 v20, v182, v34, v20
    v_dot2_f32_bf16 v21, v182, v38, v21
    v_dot2_f32_bf16 v22, v186, v34, v22
    v_dot2_f32_bf16 v23, v186, v38, v23
    v_dot2_f32_bf16 v24, v190, v34, v24
    v_dot2_f32_bf16 v25, v190, v38, v25
    v_dot2_f32_bf16 v26, v194, v34, v26
    v_dot2_f32_bf16 v27, v194, v38, v27
    v_dot2_f32_bf16 v28, v198, v34, v28
    v_dot2_f32_bf16 v29, v198, v38, v29
    v_dot2_f32_bf16 v30, v202, v34, v30
    v_dot2_f32_bf16 v31, v202, v38, v31
    v_dot2_f32_bf16 v16, v175, v35, v16
    v_dot2_f32_bf16 v17, v175, v39, v17
    v_dot2_f32_bf16 v18, v179, v35, v18
    v_dot2_f32_bf16 v19, v179, v39, v19
    v_dot2_f32_bf16 v20, v183, v35, v20
    v_dot2_f32_bf16 v21, v183, v39, v21
    v_dot2_f32_bf16 v22, v187, v35, v22
    v_dot2_f32_bf16 v23, v187, v39, v23
    v_dot2_f32_bf16 v24, v191, v35, v24
    v_dot2_f32_bf16 v25, v191, v39, v25
    v_dot2_f32_bf16 v26, v195, v35, v26
    v_dot2_f32_bf16 v27, v195, v39, v27
    v_dot2_f32_bf16 v28, v199, v35, v28
    v_dot2_f32_bf16 v29, v199, v39, v29
    v_dot2_f32_bf16 v30, v203, v35, v30
    v_dot2_f32_bf16 v31, v203, v39, v31
    s_nop 3
    s_nop 1
    v_add_f32_dpp v16, v16, v16 row_ror:8 row_mask:0xf bank_mask:0xf
    v_add_f32_dpp v17, v17, v17 row_ror:8 row_mask:0xf bank_mask:0xf
    v_add_f32_dpp v18, v18, v18 row_ror:8 row_mask:0xf bank_mask:0xf
    v_add_f32_dpp v19, v19, v19 row_ror:8 row_mask:0xf bank_mask:0xf
    v_add_f32_dpp v20, v20, v20 row_ror:8 row_mask:0xf bank_mask:0xf
    v_add_f32_dpp v21, v21, v21 row_ror:8 row_mask:0xf bank_mask:0xf
    v_add_f32_dpp v22, v22, v22 row_ror:8 row_mask:0xf bank_mask:0xf
    v_add_f32_dpp v23, v23, v23 row_ror:8 row_mask:0xf bank_mask:0xf
    v_add_f32_dpp v24, v24, v24 row_ror:8 row_mask:0xf bank_mask:0xf
    v_add_f32_dpp v25, v25, v25 row_ror:8 row_mask:0xf bank_mask:0xf
    v_add_f32_dpp v26, v26, v26 row_ror:8 row_mask:0xf bank_mask:0xf
    v_add_f32_dpp v27, v27, v27 row_ror:8 row_mask:0xf bank_mask:0xf
    v_add_f32_dpp v28, v28, v28 row_ror:8 row_mask:0xf bank_mask:0xf
    v_add_f32_dpp v29, v29, v29 row_ror:8 row_mask:0xf bank_mask:0xf
    v_add_f32_dpp v30, v30, v30 row_ror:8 row_mask:0xf bank_mask:0xf
    v_add_f32_dpp v31, v31, v31 row_ror:8 row_mask:0xf bank_mask:0xf
    s_nop 1
    v_add_f32_dpp v16, v16, v16 row_ror:4 row_mask:0xf bank_mask:0xf
    v_add_f32_dpp v17, v17, v17 row_ror:4 row_mask:0xf bank_mask:0xf
    v_add_f32_dpp v18, v18, v18 row_ror:4 row_mask:0xf bank_mask:0xf
    v_add_f32_dpp v19, v19, v19 row_ror:4 row_mask:0xf bank_mask:0xf
    v_add_f32_dpp v20, v20, v20 row_ror:4 row_mask:0xf bank_mask:0xf
    v_add_f32_dpp v21, v21, v21 row_ror:4 row_mask:0xf bank_mask:0xf
    v_add_f32_dpp v22, v22, v22 row_ror:4 row_mask:0xf bank_mask:0xf
    v_add_f32_dpp v23, v23, v23 row_ror:4 row_mask:0xf bank_mask:0xf
    v_add_f32_dpp v24, v24, v24 row_ror:4 row_mask:0xf bank_mask:0xf
    v_add_f32_dpp v25, v25, v25 row_ror:4 row_mask:0xf bank_mask:0xf
    v_add_f32_dpp v26, v26, v26 row_ror:4 row_mask:0xf bank_mask:0xf
    v_add_f32_dpp v27, v27, v27 row_ror:4 row_mask:0xf bank_mask:0xf
    v_add_f32_dpp v28, v28, v28 row_ror:4 row_mask:0xf bank_mask:0xf
    v_add_f32_dpp v29, v29, v29 row_ror:4 row_mask:0xf bank_mask:0xf
    v_add_f32_dpp v30, v30, v30 row_ror:4 row_mask:0xf bank_mask:0xf
    v_add_f32_dpp v31, v31, v31 row_ror:4 row_mask:0xf bank_mask:0xf
    s_nop 1
    v_add_f32_dpp v16, v16, v16 row_ror:2 row_mask:0xf bank_mask:0xf
    v_add_f32_dpp v17, v17, v17 row_ror:2 row_mask:0xf bank_mask:0xf
    v_add_f32_dpp v18, v18, v18 row_ror:2 row_mask:0xf bank_mask:0xf
    v_add_f32_dpp v19, v19, v19 row_ror:2 row_mask:0xf bank_mask:0xf
    v_add_f32_dpp v20, v20, v20 row_ror:2 row_mask:0xf bank_mask:0xf
    v_add_f32_dpp v21, v21, v21 row_ror:2 row_mask:0xf bank_mask:0xf
    v_add_f32_dpp v22, v22, v22 row_ror:2 row_mask:0xf bank_mask:0xf
    v_add_f32_dpp v23, v23, v23 row_ror:2 row_mask:0xf bank_mask:0xf
    v_add_f32_dpp v24, v24, v24 row_ror:2 row_mask:0xf bank_mask:0xf
    v_add_f32_dpp v25, v25, v25 row_ror:2 row_mask:0xf bank_mask:0xf
    v_add_f32_dpp v26, v26, v26 row_ror:2 row_mask:0xf bank_mask:0xf
    v_add_f32_dpp v27, v27, v27 row_ror:2 row_mask:0xf bank_mask:0xf
    v_add_f32_dpp v28, v28, v28 row_ror:2 row_mask:0xf bank_mask:0xf
    v_add_f32_dpp v29, v29, v29 row_ror:2 row_mask:0xf bank_mask:0xf
    v_add_f32_dpp v30, v30, v30 row_ror:2 row_mask:0xf bank_mask:0xf
    v_add_f32_dpp v31, v31, v31 row_ror:2 row_mask:0xf bank_mask:0xf
    s_nop 1
    v_add_f32_dpp v16, v16, v16 row_ror:1 row_mask:0xf bank_mask:0xf
    v_add_f32_dpp v17, v17, v17 row_ror:1 row_mask:0xf bank_mask:0xf
    v_add_f32_dpp v18, v18, v18 row_ror:1 row_mask:0xf bank_mask:0xf
    v_add_f32_dpp v19, v19, v19 row_ror:1 row_mask:0xf bank_mask:0xf
    v_add_f32_dpp v20, v20, v20 row_ror:1 row_mask:0xf bank_mask:0xf
    v_add_f32_dpp v21, v21, v21 row_ror:1 row_mask:0xf bank_mask:0xf
    v_add_f32_dpp v22, v22, v22 row_ror:1 row_mask:0xf bank_mask:0xf
    v_add_f32_dpp v23, v23, v23 row_ror:1 row_mask:0xf bank_mask:0xf
    v_add_f32_dpp v24, v24, v24 row_ror:1 row_mask:0xf bank_mask:0xf
    v_add_f32_dpp v25, v25, v25 row_ror:1 row_mask:0xf bank_mask:0xf
    v_add_f32_dpp v26, v26, v26 row_ror:1 row_mask:0xf bank_mask:0xf
    v_add_f32_dpp v27, v27, v27 row_ror:1 row_mask:0xf bank_mask:0xf
    v_add_f32_dpp v28, v28, v28 row_ror:1 row_mask:0xf bank_mask:0xf
    v_add_f32_dpp v29, v29, v29 row_ror:1 row_mask:0xf bank_mask:0xf
    v_add_f32_dpp v30, v30, v30 row_ror:1 row_mask:0xf bank_mask:0xf
    v_add_f32_dpp v31, v31, v31 row_ror:1 row_mask:0xf bank_mask:0xf
    s_nop 1
    v_cmp_eq_u32 vcc, 1, v4
    s_nop 1
    v_cndmask_b32 v16, v16, v18, vcc
    v_cndmask_b32 v17, v17, v19, vcc
    v_cmp_eq_u32 vcc, 2, v4
    s_nop 1
    v_cndmask_b32 v16, v16, v20, vcc
    v_cndmask_b32 v17, v17, v21, vcc
    v_cmp_eq_u32 vcc, 3, v4
    s_nop 1
    v_cndmask_b32 v16, v16, v22, vcc
    v_cndmask_b32 v17, v17, v23, vcc
    v_cmp_eq_u32 vcc, 4, v4
    s_nop 1
    v_cndmask_b32 v16, v16, v24, vcc
    v_cndmask_b32 v17, v17, v25, vcc
    v_cmp_eq_u32 vcc, 5, v4
    s_nop 1
    v_cndmask_b32 v16, v16, v26, vcc
    v_cndmask_b32 v17, v17, v27, vcc
    v_cmp_eq_u32 vcc, 6, v4
    s_nop 1
    v_cndmask_b32 v16, v16, v28, vcc
    v_cndmask_b32 v17, v17, v29, vcc
    v_cmp_eq_u32 vcc, 7, v4
    s_nop 1
    v_cndmask_b32 v16, v16, v30, vcc
    v_cndmask_b32 v17, v17, v31, vcc
    v_cvt_pk_bf16_f32 v16, v16, v16
    v_cvt_pk_bf16_f32 v17, v17, v17
    s_lshl_b32 s55, s56, 10
    s_lshl_b32 s58, s57, 9
    s_add_u32 s55, s55, s58
    s_add_u32 s55, s55, 32768
    s_add_u32 s58, s55, 32768
    v_lshl_add_u32 v5, v4, 5, v7
    v_lshlrev_b32 v5, 1, v5
    v_cmp_gt_u32 vcc, 8, v4
    s_and_saveexec_b64 s[62:63], vcc
    buffer_store_short v16, v5, s[32:35], s55 offen sc1
    buffer_store_short v17, v5, s[32:35], s58 offen sc1
    s_mov_b64 exec, s[62:63]
    s_waitcnt vmcnt(0)
    s_barrier
    s_cmp_lg_u32 s60, 0
    s_cbranch_scc1 W0E_14
    s_mov_b64 s[62:63], exec
    s_mov_b64 exec, 1
    v_mov_b32 v6, 0
    s_mov_b32 s64, 0
POLL_15:
    buffer_load_dword v5, v6, s[36:39], 0 offen sc1
    s_waitcnt vmcnt(0)
    v_cmp_le_u32 vcc, 1, v5
    s_nop 3
    s_cmp_eq_u64 vcc, exec
    s_cbranch_scc1 PDONE_16
    s_add_u32 s64, s64, 1
    s_cmp_gt_u32 s64, 0x20000
    s_cbranch_scc1 PDONE_16
    s_sleep 2
    s_branch POLL_15
PDONE_16:
    s_mov_b64 exec, s[62:63]
    s_and_b32 s55, s2, 7
    s_lshl_b32 s55, s55, 2
    s_add_u32 s55, s55, 192
    s_mov_b64 s[62:63], exec
    s_mov_b64 exec, 1
    v_mov_b32 v5, 1
    v_mov_b32 v6, s55
    v_lshlrev_b32 v6, 5, v6
    v_add_u32 v6, 7864320, v6
    buffer_atomic_add v5, v6, s[32:35], 0 offen
    s_mov_b64 exec, s[62:63]
W0E_14:
    s_cmp_eq_u32 s60, 0
    s_cbranch_scc1 BC_SKIP
    s_mov_b32 s55, 0
    buffer_load_dwordx4 v[64:67], v12, s[28:31], s55 offen offset:0 nt
    buffer_load_dwordx4 v[68:71], v12, s[28:31], s55 offen offset:1024 nt
    buffer_load_dwordx4 v[72:75], v12, s[28:31], s55 offen offset:2048 nt
    buffer_load_dwordx4 v[76:79], v12, s[28:31], s55 offen offset:3072 nt
    s_mov_b32 s55, 4096
    buffer_load_dwordx4 v[80:83], v12, s[28:31], s55 offen offset:0 nt
    buffer_load_dwordx4 v[84:87], v12, s[28:31], s55 offen offset:1024 nt
    buffer_load_dwordx4 v[88:91], v12, s[28:31], s55 offen offset:2048 nt
    buffer_load_dwordx4 v[92:95], v12, s[28:31], s55 offen offset:3072 nt
    s_mov_b32 s55, 8192
    buffer_load_dwordx4 v[96:99], v12, s[28:31], s55 offen offset:0 nt
    s_mov_b32 s55, 8192
    s_cmp_eq_u32 s60, 7
    s_cselect_b32 s55, s55, 0x7fff0000
    buffer_load_dwordx4 v[100:103], v12, s[28:31], s55 offen offset:1024 nt
    s_mov_b32 s55, 65536
    buffer_load_dwordx4 v[104:107], v12, s[28:31], s55 offen offset:0 nt
    buffer_load_dwordx4 v[108:111], v12, s[28:31], s55 offen offset:1024 nt
    buffer_load_dwordx4 v[112:115], v12, s[28:31], s55 offen offset:2048 nt
    buffer_load_dwordx4 v[116:119], v12, s[28:31], s55 offen offset:3072 nt
    s_mov_b32 s55, 69632
    buffer_load_dwordx4 v[120:123], v12, s[28:31], s55 offen offset:0 nt
    buffer_load_dwordx4 v[124:127], v12, s[28:31], s55 offen offset:1024 nt
    buffer_load_dwordx4 v[128:131], v12, s[28:31], s55 offen offset:2048 nt
    buffer_load_dwordx4 v[132:135], v12, s[28:31], s55 offen offset:3072 nt
    s_mov_b32 s55, 73728
    buffer_load_dwordx4 v[136:139], v12, s[28:31], s55 offen offset:0 nt
    s_mov_b32 s55, 73728
    s_cmp_eq_u32 s60, 7
    s_cselect_b32 s55, s55, 0x7fff0000
    buffer_load_dwordx4 v[140:143], v12, s[28:31], s55 offen offset:1024 nt
BC_SKIP:
    s_cmp_lg_u32 s60, 0
    s_cbranch_scc1 W0E_17
    s_mov_b32 s55, 192
    s_mov_b64 s[62:63], exec
    s_mov_b64 exec, 255
    v_lshlrev_b32 v6, 2, v2
    v_add_u32 v6, s55, v6
    v_lshlrev_b32 v6, 5, v6
    v_add_u32 v6, 7864320, v6
    s_mov_b32 s64, 0
POLL_18:
    buffer_load_dword v5, v6, s[32:35], 0 offen sc1
    s_waitcnt vmcnt(0)
    v_cmp_le_u32 vcc, 8, v5
    s_nop 3
    s_cmp_eq_u64 vcc, exec
    s_cbranch_scc1 PDONE_19
    s_add_u32 s64, s64, 1
    s_cmp_gt_u32 s64, 0x20000
    s_cbranch_scc1 PDONE_19
    s_sleep 2
    s_branch POLL_18
PDONE_19:
    s_mov_b64 exec, s[62:63]
    s_lshr_b32 s55, s96, 5
    s_lshl_b32 s55, s55, 15
    s_add_u32 s55, s55, 32768
    v_lshlrev_b32 v5, 4, v2
    buffer_load_dwordx4 v[64:67], v5, s[32:35], s55 offen offset:0 sc1
    buffer_load_dwordx4 v[68:71], v5, s[32:35], s55 offen offset:1024 sc1
    buffer_load_dwordx4 v[72:75], v5, s[32:35], s55 offen offset:2048 sc1
    buffer_load_dwordx4 v[76:79], v5, s[32:35], s55 offen offset:3072 sc1
    s_add_u32 s55, s55, 4096
    buffer_load_dwordx4 v[80:83], v5, s[32:35], s55 offen offset:0 sc1
    buffer_load_dwordx4 v[84:87], v5, s[32:35], s55 offen offset:1024 sc1
    buffer_load_dwordx4 v[88:91], v5, s[32:35], s55 offen offset:2048 sc1
    buffer_load_dwordx4 v[92:95], v5, s[32:35], s55 offen offset:3072 sc1
    s_add_u32 s55, s55, 4096
    buffer_load_dwordx4 v[96:99], v5, s[32:35], s55 offen offset:0 sc1
    buffer_load_dwordx4 v[100:103], v5, s[32:35], s55 offen offset:1024 sc1
    buffer_load_dwordx4 v[104:107], v5, s[32:35], s55 offen offset:2048 sc1
    buffer_load_dwordx4 v[108:111], v5, s[32:35], s55 offen offset:3072 sc1
    s_add_u32 s55, s55, 4096
    buffer_load_dwordx4 v[112:115], v5, s[32:35], s55 offen offset:0 sc1
    buffer_load_dwordx4 v[116:119], v5, s[32:35], s55 offen offset:1024 sc1
    buffer_load_dwordx4 v[120:123], v5, s[32:35], s55 offen offset:2048 sc1
    buffer_load_dwordx4 v[124:127], v5, s[32:35], s55 offen offset:3072 sc1
    s_add_u32 s55, s55, 4096
    buffer_load_dwordx4 v[128:131], v5, s[32:35], s55 offen offset:0 sc1
    buffer_load_dwordx4 v[132:135], v5, s[32:35], s55 offen offset:1024 sc1
    buffer_load_dwordx4 v[136:139], v5, s[32:35], s55 offen offset:2048 sc1
    buffer_load_dwordx4 v[140:143], v5, s[32:35], s55 offen offset:3072 sc1
    s_add_u32 s55, s55, 4096
    buffer_load_dwordx4 v[144:147], v5, s[32:35], s55 offen offset:0 sc1
    buffer_load_dwordx4 v[148:151], v5, s[32:35], s55 offen offset:1024 sc1
    buffer_load_dwordx4 v[152:155], v5, s[32:35], s55 offen offset:2048 sc1
    buffer_load_dwordx4 v[156:159], v5, s[32:35], s55 offen offset:3072 sc1
    s_add_u32 s55, s55, 4096
    buffer_load_dwordx4 v[160:163], v5, s[32:35], s55 offen offset:0 sc1
    buffer_load_dwordx4 v[164:167], v5, s[32:35], s55 offen offset:1024 sc1
    buffer_load_dwordx4 v[168:171], v5, s[32:35], s55 offen offset:2048 sc1
    buffer_load_dwordx4 v[172:175], v5, s[32:35], s55 offen offset:3072 sc1
    s_add_u32 s55, s55, 4096
    buffer_load_dwordx4 v[176:179], v5, s[32:35], s55 offen offset:0 sc1
    buffer_load_dwordx4 v[180:183], v5, s[32:35], s55 offen offset:1024 sc1
    buffer_load_dwordx4 v[184:187], v5, s[32:35], s55 offen offset:2048 sc1
    buffer_load_dwordx4 v[188:191], v5, s[32:35], s55 offen offset:3072 sc1
    s_add_u32 s55, s55, 4096
    v_add_u32 v6, 5632, v5
    s_waitcnt vmcnt(31)
    ds_write_b128 v6, v[64:67] offset:0
    s_waitcnt vmcnt(30)
    ds_write_b128 v6, v[68:71] offset:1040
    s_waitcnt vmcnt(29)
    ds_write_b128 v6, v[72:75] offset:2080
    s_waitcnt vmcnt(28)
    ds_write_b128 v6, v[76:79] offset:3120
    s_waitcnt vmcnt(27)
    ds_write_b128 v6, v[80:83] offset:4160
    s_waitcnt vmcnt(26)
    ds_write_b128 v6, v[84:87] offset:5200
    s_waitcnt vmcnt(25)
    ds_write_b128 v6, v[88:91] offset:6240
    s_waitcnt vmcnt(24)
    ds_write_b128 v6, v[92:95] offset:7280
    s_waitcnt vmcnt(23)
    ds_write_b128 v6, v[96:99] offset:8320
    s_waitcnt vmcnt(22)
    ds_write_b128 v6, v[100:103] offset:9360
    s_waitcnt vmcnt(21)
    ds_write_b128 v6, v[104:107] offset:10400
    s_waitcnt vmcnt(20)
    ds_write_b128 v6, v[108:111] offset:11440
    s_waitcnt vmcnt(19)
    ds_write_b128 v6, v[112:115] offset:12480
    s_waitcnt vmcnt(18)
    ds_write_b128 v6, v[116:119] offset:13520
    s_waitcnt vmcnt(17)
    ds_write_b128 v6, v[120:123] offset:14560
    s_waitcnt vmcnt(16)
    ds_write_b128 v6, v[124:127] offset:15600
    s_waitcnt vmcnt(15)
    ds_write_b128 v6, v[128:131] offset:16640
    s_waitcnt vmcnt(14)
    ds_write_b128 v6, v[132:135] offset:17680
    s_waitcnt vmcnt(13)
    ds_write_b128 v6, v[136:139] offset:18720
    s_waitcnt vmcnt(12)
    ds_write_b128 v6, v[140:143] offset:19760
    s_waitcnt vmcnt(11)
    ds_write_b128 v6, v[144:147] offset:20800
    s_waitcnt vmcnt(10)
    ds_write_b128 v6, v[148:151] offset:21840
    s_waitcnt vmcnt(9)
    ds_write_b128 v6, v[152:155] offset:22880
    s_waitcnt vmcnt(8)
    ds_write_b128 v6, v[156:159] offset:23920
    s_waitcnt vmcnt(7)
    ds_write_b128 v6, v[160:163] offset:24960
    s_waitcnt vmcnt(6)
    ds_write_b128 v6, v[164:167] offset:26000
    s_waitcnt vmcnt(5)
    ds_write_b128 v6, v[168:171] offset:27040
    s_waitcnt vmcnt(4)
    ds_write_b128 v6, v[172:175] offset:28080
    s_waitcnt vmcnt(3)
    ds_write_b128 v6, v[176:179] offset:29120
    s_waitcnt vmcnt(2)
    ds_write_b128 v6, v[180:183] offset:30160
    s_waitcnt vmcnt(1)
    ds_write_b128 v6, v[184:187] offset:31200
    s_waitcnt vmcnt(0)
    ds_write_b128 v6, v[188:191] offset:32240
W0E_17:
    v_subrev_u32 v6, 1, v1
    v_max_i32 v6, 0, v6
    v_mul_u32_u24 v6, 9360, v6
    v_lshl_add_u32 v6, v2, 4, v6
    v_add_u32 v6, 38912, v6
    v_and_b32 v7, 1, v1
    v_lshrrev_b32 v8, 1, v1
    v_lshl_add_u32 v9, v7, 4, v4
    v_mul_u32_u24 v9, 1040, v9
    v_lshl_add_u32 v9, v3, 4, v9
    v_add_u32 v9, 5632, v9
    v_lshl_add_u32 v10, v8, 4, v4
    v_mul_u32_u24 v10, 1040, v10
    v_lshl_add_u32 v10, v3, 4, v10
    v_add_u32 v10, 38912, v10
    v_lshlrev_b32 v11, 7, v8
    v_lshl_add_u32 v11, v7, 6, v11
    v_lshl_add_u32 v11, v3, 4, v11
    v_lshlrev_b32 v16, 4, v3
    v_lshl_add_u32 v17, v7, 2, v3
    v_mul_u32_u24 v17, 576, v17
    v_lshl_add_u32 v18, v8, 4, v4
    v_lshl_add_u32 v17, v18, 1, v17
    v_mul_u32_u24 v18, 144, v4
    v_lshl_add_u32 v18, v3, 4, v18
    v_lshrrev_b32 v19, 2, v4
    v_lshl_add_u32 v19, v3, 3, v19
    v_mul_u32_u24 v19, 1040, v19
    v_and_b32 v20, 3, v4
    v_lshl_add_u32 v19, v20, 3, v19
    v_lshl_add_u32 v19, v1, 7, v19
    v_add_u32 v19, 38912, v19
    v_mov_b32 v20, 0xff800000
    v_mov_b32 v21, 0xff800000
    v_mov_b32 v22, 0xff800000
    v_mov_b32 v23, 0xff800000
    v_mov_b32 v24, 0xff800000
    v_mov_b32 v25, 0xff800000
    v_mov_b32 v26, 0xff800000
    v_mov_b32 v27, 0xff800000
    v_mov_b32 v28, 0
    v_mov_b32 v29, 0
    v_mov_b32 v30, 0
    v_mov_b32 v31, 0
    v_mov_b32 v224, 0
    v_mov_b32 v225, 0
    v_mov_b32 v226, 0
    v_mov_b32 v227, 0
    v_mov_b32 v228, 0
    v_mov_b32 v229, 0
    v_mov_b32 v230, 0
    v_mov_b32 v231, 0
    v_mov_b32 v232, 0
    v_mov_b32 v233, 0
    v_mov_b32 v234, 0
    v_mov_b32 v235, 0
    v_mov_b32 v236, 0
    v_mov_b32 v237, 0
    v_mov_b32 v238, 0
    v_mov_b32 v239, 0
    v_mov_b32 v240, 0
    v_mov_b32 v241, 0
    v_mov_b32 v242, 0
    v_mov_b32 v243, 0
    v_mov_b32 v244, 0
    v_mov_b32 v245, 0
    v_mov_b32 v246, 0
    v_mov_b32 v247, 0
    v_mov_b32 v248, 0
    v_mov_b32 v249, 0
    v_mov_b32 v250, 0
    v_mov_b32 v251, 0
    v_mov_b32 v252, 0
    v_mov_b32 v253, 0
    v_mov_b32 v254, 0
    v_mov_b32 v255, 0
    s_waitcnt vmcnt(10)
    s_barrier
    s_cmp_eq_u32 s60, 0
    s_cbranch_scc1 CW_20
    ds_write_b128 v6, v[64:67] offset:0
    ds_write_b128 v6, v[68:71] offset:1040
    ds_write_b128 v6, v[72:75] offset:2080
    ds_write_b128 v6, v[76:79] offset:3120
    ds_write_b128 v6, v[80:83] offset:4160
    ds_write_b128 v6, v[84:87] offset:5200
    ds_write_b128 v6, v[88:91] offset:6240
    ds_write_b128 v6, v[92:95] offset:7280
    ds_write_b128 v6, v[96:99] offset:8320
    s_cmp_lg_u32 s60, 7
    s_cbranch_scc1 CW_20
    ds_write_b128 v6, v[100:103] offset:9360
CW_20:
    s_waitcnt lgkmcnt(0)
    s_barrier
    ds_read_b128 v[32:35], v9 offset:0
    ds_read_b128 v[36:39], v10 offset:0
    ds_read_b128 v[40:43], v9 offset:64
    ds_read_b128 v[44:47], v10 offset:64
    ds_read_b128 v[48:51], v9 offset:128
    ds_read_b128 v[52:55], v10 offset:128
    ds_read_b128 v[56:59], v9 offset:192
    ds_read_b128 v[60:63], v10 offset:192
    s_waitcnt lgkmcnt(6)
    v_mfma_f32_16x16x32_bf16 v[12:15], v[32:35], v[36:39], 0
    s_waitcnt lgkmcnt(4)
    v_mfma_f32_16x16x32_bf16 v[12:15], v[40:43], v[44:47], v[12:15]
    s_waitcnt lgkmcnt(2)
    v_mfma_f32_16x16x32_bf16 v[12:15], v[48:51], v[52:55], v[12:15]
    s_waitcnt lgkmcnt(0)
    v_mfma_f32_16x16x32_bf16 v[12:15], v[56:59], v[60:63], v[12:15]
    s_nop 3
    ds_read_b128 v[32:35], v9 offset:256
    ds_read_b128 v[36:39], v10 offset:256
    ds_read_b128 v[40:43], v9 offset:320
    ds_read_b128 v[44:47], v10 offset:320
    ds_read_b128 v[48:51], v9 offset:384
    ds_read_b128 v[52:55], v10 offset:384
    ds_read_b128 v[56:59], v9 offset:448
    ds_read_b128 v[60:63], v10 offset:448
    s_waitcnt lgkmcnt(6)
    v_mfma_f32_16x16x32_bf16 v[12:15], v[32:35], v[36:39], v[12:15]
    s_waitcnt lgkmcnt(4)
    v_mfma_f32_16x16x32_bf16 v[12:15], v[40:43], v[44:47], v[12:15]
    s_waitcnt lgkmcnt(2)
    v_mfma_f32_16x16x32_bf16 v[12:15], v[48:51], v[52:55], v[12:15]
    s_waitcnt lgkmcnt(0)
    v_mfma_f32_16x16x32_bf16 v[12:15], v[56:59], v[60:63], v[12:15]
    s_nop 3
    ds_read_b128 v[32:35], v9 offset:512
    ds_read_b128 v[36:39], v10 offset:512
    ds_read_b128 v[40:43], v9 offset:576
    ds_read_b128 v[44:47], v10 offset:576
    ds_read_b128 v[48:51], v9 offset:640
    ds_read_b128 v[52:55], v10 offset:640
    ds_read_b128 v[56:59], v9 offset:704
    ds_read_b128 v[60:63], v10 offset:704
    s_waitcnt lgkmcnt(6)
    v_mfma_f32_16x16x32_bf16 v[12:15], v[32:35], v[36:39], v[12:15]
    s_waitcnt lgkmcnt(4)
    v_mfma_f32_16x16x32_bf16 v[12:15], v[40:43], v[44:47], v[12:15]
    s_waitcnt lgkmcnt(2)
    v_mfma_f32_16x16x32_bf16 v[12:15], v[48:51], v[52:55], v[12:15]
    s_waitcnt lgkmcnt(0)
    v_mfma_f32_16x16x32_bf16 v[12:15], v[56:59], v[60:63], v[12:15]
    s_nop 3
    ds_read_b128 v[32:35], v9 offset:768
    ds_read_b128 v[36:39], v10 offset:768
    ds_read_b128 v[40:43], v9 offset:832
    ds_read_b128 v[44:47], v10 offset:832
    ds_read_b128 v[48:51], v9 offset:896
    ds_read_b128 v[52:55], v10 offset:896
    ds_read_b128 v[56:59], v9 offset:960
    ds_read_b128 v[60:63], v10 offset:960
    s_waitcnt lgkmcnt(6)
    v_mfma_f32_16x16x32_bf16 v[12:15], v[32:35], v[36:39], v[12:15]
    s_waitcnt lgkmcnt(4)
    v_mfma_f32_16x16x32_bf16 v[12:15], v[40:43], v[44:47], v[12:15]
    s_waitcnt lgkmcnt(2)
    v_mfma_f32_16x16x32_bf16 v[12:15], v[48:51], v[52:55], v[12:15]
    s_waitcnt lgkmcnt(0)
    v_mfma_f32_16x16x32_bf16 v[12:15], v[56:59], v[60:63], v[12:15]
    s_nop 3
    s_nop 7
    s_nop 3
    v_mov_b32 v32, v12
    v_mov_b32 v33, v13
    v_mov_b32 v34, v14
    v_mov_b32 v35, v15
    s_nop 1
    v_max_f32_dpp v32, v32, v32 row_ror:8 row_mask:0xf bank_mask:0xf
    v_max_f32_dpp v33, v33, v33 row_ror:8 row_mask:0xf bank_mask:0xf
    v_max_f32_dpp v34, v34, v34 row_ror:8 row_mask:0xf bank_mask:0xf
    v_max_f32_dpp v35, v35, v35 row_ror:8 row_mask:0xf bank_mask:0xf
    s_nop 1
    v_max_f32_dpp v32, v32, v32 row_ror:4 row_mask:0xf bank_mask:0xf
    v_max_f32_dpp v33, v33, v33 row_ror:4 row_mask:0xf bank_mask:0xf
    v_max_f32_dpp v34, v34, v34 row_ror:4 row_mask:0xf bank_mask:0xf
    v_max_f32_dpp v35, v35, v35 row_ror:4 row_mask:0xf bank_mask:0xf
    s_nop 1
    v_max_f32_dpp v32, v32, v32 row_ror:2 row_mask:0xf bank_mask:0xf
    v_max_f32_dpp v33, v33, v33 row_ror:2 row_mask:0xf bank_mask:0xf
    v_max_f32_dpp v34, v34, v34 row_ror:2 row_mask:0xf bank_mask:0xf
    v_max_f32_dpp v35, v35, v35 row_ror:2 row_mask:0xf bank_mask:0xf
    s_nop 1
    v_max_f32_dpp v32, v32, v32 row_ror:1 row_mask:0xf bank_mask:0xf
    v_max_f32_dpp v33, v33, v33 row_ror:1 row_mask:0xf bank_mask:0xf
    v_max_f32_dpp v34, v34, v34 row_ror:1 row_mask:0xf bank_mask:0xf
    v_max_f32_dpp v35, v35, v35 row_ror:1 row_mask:0xf bank_mask:0xf
    s_nop 1
    ds_write_b128 v11, v[32:35] offset:4608
    s_waitcnt lgkmcnt(0)
    s_barrier
    ds_read_b128 v[32:35], v16 offset:4608
    ds_read_b128 v[36:39], v16 offset:4736
    ds_read_b128 v[40:43], v16 offset:4864
    ds_read_b128 v[44:47], v16 offset:4992
    ds_read_b128 v[48:51], v16 offset:4672
    ds_read_b128 v[52:55], v16 offset:4800
    ds_read_b128 v[56:59], v16 offset:4928
    ds_read_b128 v[60:63], v16 offset:5056
    s_waitcnt lgkmcnt(0)
    v_max_f32 v32, v32, v36
    v_max3_f32 v32, v32, v40, v44
    v_max_f32 v32, v32, v20
    v_sub_f32 v36, v20, v32
    v_mul_f32 v36, s61, v36
    v_exp_f32 v36, v36
    v_mov_b32 v20, v32
    v_max_f32 v33, v33, v37
    v_max3_f32 v33, v33, v41, v45
    v_max_f32 v33, v33, v21
    v_sub_f32 v37, v21, v33
    v_mul_f32 v37, s61, v37
    v_exp_f32 v37, v37
    v_mov_b32 v21, v33
    v_max_f32 v34, v34, v38
    v_max3_f32 v34, v34, v42, v46
    v_max_f32 v34, v34, v22
    v_sub_f32 v38, v22, v34
    v_mul_f32 v38, s61, v38
    v_exp_f32 v38, v38
    v_mov_b32 v22, v34
    v_max_f32 v35, v35, v39
    v_max3_f32 v35, v35, v43, v47
    v_max_f32 v35, v35, v23
    v_sub_f32 v39, v23, v35
    v_mul_f32 v39, s61, v39
    v_exp_f32 v39, v39
    v_mov_b32 v23, v35
    v_max_f32 v48, v48, v52
    v_max3_f32 v48, v48, v56, v60
    v_max_f32 v48, v48, v24
    v_sub_f32 v52, v24, v48
    v_mul_f32 v52, s61, v52
    v_exp_f32 v52, v52
    v_mov_b32 v24, v48
    v_max_f32 v49, v49, v53
    v_max3_f32 v49, v49, v57, v61
    v_max_f32 v49, v49, v25
    v_sub_f32 v53, v25, v49
    v_mul_f32 v53, s61, v53
    v_exp_f32 v53, v53
    v_mov_b32 v25, v49
    v_max_f32 v50, v50, v54
    v_max3_f32 v50, v50, v58, v62
    v_max_f32 v50, v50, v26
    v_sub_f32 v54, v26, v50
    v_mul_f32 v54, s61, v54
    v_exp_f32 v54, v54
    v_mov_b32 v26, v50
    v_max_f32 v51, v51, v55
    v_max3_f32 v51, v51, v59, v63
    v_max_f32 v51, v51, v27
    v_sub_f32 v55, v27, v51
    v_mul_f32 v55, s61, v55
    v_exp_f32 v55, v55
    v_mov_b32 v27, v51
    v_cmp_eq_u32 vcc, 1, v7
    s_nop 1
    v_cndmask_b32 v40, v20, v24, vcc
    v_cndmask_b32 v44, v36, v52, vcc
    v_cndmask_b32 v41, v21, v25, vcc
    v_cndmask_b32 v45, v37, v53, vcc
    v_cndmask_b32 v42, v22, v26, vcc
    v_cndmask_b32 v46, v38, v54, vcc
    v_cndmask_b32 v43, v23, v27, vcc
    v_cndmask_b32 v47, v39, v55, vcc
    v_sub_f32 v12, v12, v40
    v_mul_f32 v12, s61, v12
    v_exp_f32 v12, v12
    v_sub_f32 v13, v13, v41
    v_mul_f32 v13, s61, v13
    v_exp_f32 v13, v13
    v_sub_f32 v14, v14, v42
    v_mul_f32 v14, s61, v14
    v_exp_f32 v14, v14
    v_sub_f32 v15, v15, v43
    v_mul_f32 v15, s61, v15
    v_exp_f32 v15, v15
    s_nop 0
    v_fma_f32 v28, v28, v44, v12
    v_cvt_pk_bf16_f32 v40, v12, v12
    v_fma_f32 v29, v29, v45, v13
    v_cvt_pk_bf16_f32 v41, v13, v13
    v_fma_f32 v30, v30, v46, v14
    v_cvt_pk_bf16_f32 v42, v14, v14
    v_fma_f32 v31, v31, v47, v15
    v_cvt_pk_bf16_f32 v43, v15, v15
    ds_write_b16 v17, v40 offset:0
    ds_write_b16 v17, v41 offset:144
    ds_write_b16 v17, v42 offset:288
    ds_write_b16 v17, v43 offset:432
    v_mul_f32 v224, v36, v224
    v_mul_f32 v225, v37, v225
    v_mul_f32 v226, v38, v226
    v_mul_f32 v227, v39, v227
    v_mul_f32 v228, v36, v228
    v_mul_f32 v229, v37, v229
    v_mul_f32 v230, v38, v230
    v_mul_f32 v231, v39, v231
    v_mul_f32 v232, v36, v232
    v_mul_f32 v233, v37, v233
    v_mul_f32 v234, v38, v234
    v_mul_f32 v235, v39, v235
    v_mul_f32 v236, v36, v236
    v_mul_f32 v237, v37, v237
    v_mul_f32 v238, v38, v238
    v_mul_f32 v239, v39, v239
    v_mul_f32 v240, v52, v240
    v_mul_f32 v241, v53, v241
    v_mul_f32 v242, v54, v242
    v_mul_f32 v243, v55, v243
    v_mul_f32 v244, v52, v244
    v_mul_f32 v245, v53, v245
    v_mul_f32 v246, v54, v246
    v_mul_f32 v247, v55, v247
    v_mul_f32 v248, v52, v248
    v_mul_f32 v249, v53, v249
    v_mul_f32 v250, v54, v250
    v_mul_f32 v251, v55, v251
    v_mul_f32 v252, v52, v252
    v_mul_f32 v253, v53, v253
    v_mul_f32 v254, v54, v254
    v_mul_f32 v255, v55, v255
    s_waitcnt lgkmcnt(0)
    s_barrier
    ds_read_b128 v[32:35], v18 offset:0
    ds_read_b128 v[36:39], v18 offset:64
    ds_read_b128 v[40:43], v18 offset:2304
    ds_read_b128 v[44:47], v18 offset:2368
    ds_read_b64_tr_b16 v[48:49], v19 offset:0
    ds_read_b64_tr_b16 v[50:51], v19 offset:4160
    ds_read_b64_tr_b16 v[52:53], v19 offset:33280
    ds_read_b64_tr_b16 v[54:55], v19 offset:37440
    ds_read_b64_tr_b16 v[56:57], v19 offset:32
    ds_read_b64_tr_b16 v[58:59], v19 offset:4192
    ds_read_b64_tr_b16 v[60:61], v19 offset:33312
    ds_read_b64_tr_b16 v[62:63], v19 offset:37472
    s_waitcnt lgkmcnt(4)
    v_mfma_f32_16x16x32_bf16 v[224:227], v[32:35], v[48:51], v[224:227]
    v_mfma_f32_16x16x32_bf16 v[240:243], v[40:43], v[48:51], v[240:243]
    v_mfma_f32_16x16x32_bf16 v[224:227], v[36:39], v[52:55], v[224:227]
    v_mfma_f32_16x16x32_bf16 v[240:243], v[44:47], v[52:55], v[240:243]
    s_waitcnt lgkmcnt(0)
    v_mfma_f32_16x16x32_bf16 v[228:231], v[32:35], v[56:59], v[228:231]
    v_mfma_f32_16x16x32_bf16 v[244:247], v[40:43], v[56:59], v[244:247]
    v_mfma_f32_16x16x32_bf16 v[228:231], v[36:39], v[60:63], v[228:231]
    v_mfma_f32_16x16x32_bf16 v[244:247], v[44:47], v[60:63], v[244:247]
    s_nop 3
    ds_read_b64_tr_b16 v[48:49], v19 offset:64
    ds_read_b64_tr_b16 v[50:51], v19 offset:4224
    ds_read_b64_tr_b16 v[52:53], v19 offset:33344
    ds_read_b64_tr_b16 v[54:55], v19 offset:37504
    ds_read_b64_tr_b16 v[56:57], v19 offset:96
    ds_read_b64_tr_b16 v[58:59], v19 offset:4256
    ds_read_b64_tr_b16 v[60:61], v19 offset:33376
    ds_read_b64_tr_b16 v[62:63], v19 offset:37536
    s_waitcnt lgkmcnt(4)
    v_mfma_f32_16x16x32_bf16 v[232:235], v[32:35], v[48:51], v[232:235]
    v_mfma_f32_16x16x32_bf16 v[248:251], v[40:43], v[48:51], v[248:251]
    v_mfma_f32_16x16x32_bf16 v[232:235], v[36:39], v[52:55], v[232:235]
    v_mfma_f32_16x16x32_bf16 v[248:251], v[44:47], v[52:55], v[248:251]
    s_waitcnt lgkmcnt(0)
    v_mfma_f32_16x16x32_bf16 v[236:239], v[32:35], v[56:59], v[236:239]
    v_mfma_f32_16x16x32_bf16 v[252:255], v[40:43], v[56:59], v[252:255]
    v_mfma_f32_16x16x32_bf16 v[236:239], v[36:39], v[60:63], v[236:239]
    v_mfma_f32_16x16x32_bf16 v[252:255], v[44:47], v[60:63], v[252:255]
    s_nop 3
    s_nop 7
    s_nop 3
    s_waitcnt vmcnt(0)
    s_barrier
    s_cmp_eq_u32 s60, 0
    s_cbranch_scc1 CW_21
    ds_write_b128 v6, v[104:107] offset:0
    ds_write_b128 v6, v[108:111] offset:1040
    ds_write_b128 v6, v[112:115] offset:2080
    ds_write_b128 v6, v[116:119] offset:3120
    ds_write_b128 v6, v[120:123] offset:4160
    ds_write_b128 v6, v[124:127] offset:5200
    ds_write_b128 v6, v[128:131] offset:6240
    ds_write_b128 v6, v[132:135] offset:7280
    ds_write_b128 v6, v[136:139] offset:8320
    s_cmp_lg_u32 s60, 7
    s_cbranch_scc1 CW_21
    ds_write_b128 v6, v[140:143] offset:9360
CW_21:
    s_waitcnt lgkmcnt(0)
    s_barrier
    ds_read_b128 v[32:35], v9 offset:0
    ds_read_b128 v[36:39], v10 offset:0
    ds_read_b128 v[40:43], v9 offset:64
    ds_read_b128 v[44:47], v10 offset:64
    ds_read_b128 v[48:51], v9 offset:128
    ds_read_b128 v[52:55], v10 offset:128
    ds_read_b128 v[56:59], v9 offset:192
    ds_read_b128 v[60:63], v10 offset:192
    s_waitcnt lgkmcnt(6)
    v_mfma_f32_16x16x32_bf16 v[12:15], v[32:35], v[36:39], 0
    s_waitcnt lgkmcnt(4)
    v_mfma_f32_16x16x32_bf16 v[12:15], v[40:43], v[44:47], v[12:15]
    s_waitcnt lgkmcnt(2)
    v_mfma_f32_16x16x32_bf16 v[12:15], v[48:51], v[52:55], v[12:15]
    s_waitcnt lgkmcnt(0)
    v_mfma_f32_16x16x32_bf16 v[12:15], v[56:59], v[60:63], v[12:15]
    s_nop 3
    ds_read_b128 v[32:35], v9 offset:256
    ds_read_b128 v[36:39], v10 offset:256
    ds_read_b128 v[40:43], v9 offset:320
    ds_read_b128 v[44:47], v10 offset:320
    ds_read_b128 v[48:51], v9 offset:384
    ds_read_b128 v[52:55], v10 offset:384
    ds_read_b128 v[56:59], v9 offset:448
    ds_read_b128 v[60:63], v10 offset:448
    s_waitcnt lgkmcnt(6)
    v_mfma_f32_16x16x32_bf16 v[12:15], v[32:35], v[36:39], v[12:15]
    s_waitcnt lgkmcnt(4)
    v_mfma_f32_16x16x32_bf16 v[12:15], v[40:43], v[44:47], v[12:15]
    s_waitcnt lgkmcnt(2)
    v_mfma_f32_16x16x32_bf16 v[12:15], v[48:51], v[52:55], v[12:15]
    s_waitcnt lgkmcnt(0)
    v_mfma_f32_16x16x32_bf16 v[12:15], v[56:59], v[60:63], v[12:15]
    s_nop 3
    ds_read_b128 v[32:35], v9 offset:512
    ds_read_b128 v[36:39], v10 offset:512
    ds_read_b128 v[40:43], v9 offset:576
    ds_read_b128 v[44:47], v10 offset:576
    ds_read_b128 v[48:51], v9 offset:640
    ds_read_b128 v[52:55], v10 offset:640
    ds_read_b128 v[56:59], v9 offset:704
    ds_read_b128 v[60:63], v10 offset:704
    s_waitcnt lgkmcnt(6)
    v_mfma_f32_16x16x32_bf16 v[12:15], v[32:35], v[36:39], v[12:15]
    s_waitcnt lgkmcnt(4)
    v_mfma_f32_16x16x32_bf16 v[12:15], v[40:43], v[44:47], v[12:15]
    s_waitcnt lgkmcnt(2)
    v_mfma_f32_16x16x32_bf16 v[12:15], v[48:51], v[52:55], v[12:15]
    s_waitcnt lgkmcnt(0)
    v_mfma_f32_16x16x32_bf16 v[12:15], v[56:59], v[60:63], v[12:15]
    s_nop 3
    ds_read_b128 v[32:35], v9 offset:768
    ds_read_b128 v[36:39], v10 offset:768
    ds_read_b128 v[40:43], v9 offset:832
    ds_read_b128 v[44:47], v10 offset:832
    ds_read_b128 v[48:51], v9 offset:896
    ds_read_b128 v[52:55], v10 offset:896
    ds_read_b128 v[56:59], v9 offset:960
    ds_read_b128 v[60:63], v10 offset:960
    s_waitcnt lgkmcnt(6)
    v_mfma_f32_16x16x32_bf16 v[12:15], v[32:35], v[36:39], v[12:15]
    s_waitcnt lgkmcnt(4)
    v_mfma_f32_16x16x32_bf16 v[12:15], v[40:43], v[44:47], v[12:15]
    s_waitcnt lgkmcnt(2)
    v_mfma_f32_16x16x32_bf16 v[12:15], v[48:51], v[52:55], v[12:15]
    s_waitcnt lgkmcnt(0)
    v_mfma_f32_16x16x32_bf16 v[12:15], v[56:59], v[60:63], v[12:15]
    s_nop 3
    s_nop 7
    s_nop 3
    v_mov_b32 v32, v12
    v_mov_b32 v33, v13
    v_mov_b32 v34, v14
    v_mov_b32 v35, v15
    s_nop 1
    v_max_f32_dpp v32, v32, v32 row_ror:8 row_mask:0xf bank_mask:0xf
    v_max_f32_dpp v33, v33, v33 row_ror:8 row_mask:0xf bank_mask:0xf
    v_max_f32_dpp v34, v34, v34 row_ror:8 row_mask:0xf bank_mask:0xf
    v_max_f32_dpp v35, v35, v35 row_ror:8 row_mask:0xf bank_mask:0xf
    s_nop 1
    v_max_f32_dpp v32, v32, v32 row_ror:4 row_mask:0xf bank_mask:0xf
    v_max_f32_dpp v33, v33, v33 row_ror:4 row_mask:0xf bank_mask:0xf
    v_max_f32_dpp v34, v34, v34 row_ror:4 row_mask:0xf bank_mask:0xf
    v_max_f32_dpp v35, v35, v35 row_ror:4 row_mask:0xf bank_mask:0xf
    s_nop 1
    v_max_f32_dpp v32, v32, v32 row_ror:2 row_mask:0xf bank_mask:0xf
    v_max_f32_dpp v33, v33, v33 row_ror:2 row_mask:0xf bank_mask:0xf
    v_max_f32_dpp v34, v34, v34 row_ror:2 row_mask:0xf bank_mask:0xf
    v_max_f32_dpp v35, v35, v35 row_ror:2 row_mask:0xf bank_mask:0xf
    s_nop 1
    v_max_f32_dpp v32, v32, v32 row_ror:1 row_mask:0xf bank_mask:0xf
    v_max_f32_dpp v33, v33, v33 row_ror:1 row_mask:0xf bank_mask:0xf
    v_max_f32_dpp v34, v34, v34 row_ror:1 row_mask:0xf bank_mask:0xf
    v_max_f32_dpp v35, v35, v35 row_ror:1 row_mask:0xf bank_mask:0xf
    s_nop 1
    ds_write_b128 v11, v[32:35] offset:4608
    s_waitcnt lgkmcnt(0)
    s_barrier
    ds_read_b128 v[32:35], v16 offset:4608
    ds_read_b128 v[36:39], v16 offset:4736
    ds_read_b128 v[40:43], v16 offset:4864
    ds_read_b128 v[44:47], v16 offset:4992
    ds_read_b128 v[48:51], v16 offset:4672
    ds_read_b128 v[52:55], v16 offset:4800
    ds_read_b128 v[56:59], v16 offset:4928
    ds_read_b128 v[60:63], v16 offset:5056
    s_waitcnt lgkmcnt(0)
    v_max_f32 v32, v32, v36
    v_max3_f32 v32, v32, v40, v44
    v_max_f32 v32, v32, v20
    v_sub_f32 v36, v20, v32
    v_mul_f32 v36, s61, v36
    v_exp_f32 v36, v36
    v_mov_b32 v20, v32
    v_max_f32 v33, v33, v37
    v_max3_f32 v33, v33, v41, v45
    v_max_f32 v33, v33, v21
    v_sub_f32 v37, v21, v33
    v_mul_f32 v37, s61, v37
    v_exp_f32 v37, v37
    v_mov_b32 v21, v33
    v_max_f32 v34, v34, v38
    v_max3_f32 v34, v34, v42, v46
    v_max_f32 v34, v34, v22
    v_sub_f32 v38, v22, v34
    v_mul_f32 v38, s61, v38
    v_exp_f32 v38, v38
    v_mov_b32 v22, v34
    v_max_f32 v35, v35, v39
    v_max3_f32 v35, v35, v43, v47
    v_max_f32 v35, v35, v23
    v_sub_f32 v39, v23, v35
    v_mul_f32 v39, s61, v39
    v_exp_f32 v39, v39
    v_mov_b32 v23, v35
    v_max_f32 v48, v48, v52
    v_max3_f32 v48, v48, v56, v60
    v_max_f32 v48, v48, v24
    v_sub_f32 v52, v24, v48
    v_mul_f32 v52, s61, v52
    v_exp_f32 v52, v52
    v_mov_b32 v24, v48
    v_max_f32 v49, v49, v53
    v_max3_f32 v49, v49, v57, v61
    v_max_f32 v49, v49, v25
    v_sub_f32 v53, v25, v49
    v_mul_f32 v53, s61, v53
    v_exp_f32 v53, v53
    v_mov_b32 v25, v49
    v_max_f32 v50, v50, v54
    v_max3_f32 v50, v50, v58, v62
    v_max_f32 v50, v50, v26
    v_sub_f32 v54, v26, v50
    v_mul_f32 v54, s61, v54
    v_exp_f32 v54, v54
    v_mov_b32 v26, v50
    v_max_f32 v51, v51, v55
    v_max3_f32 v51, v51, v59, v63
    v_max_f32 v51, v51, v27
    v_sub_f32 v55, v27, v51
    v_mul_f32 v55, s61, v55
    v_exp_f32 v55, v55
    v_mov_b32 v27, v51
    v_cmp_eq_u32 vcc, 1, v7
    s_nop 1
    v_cndmask_b32 v40, v20, v24, vcc
    v_cndmask_b32 v44, v36, v52, vcc
    v_cndmask_b32 v41, v21, v25, vcc
    v_cndmask_b32 v45, v37, v53, vcc
    v_cndmask_b32 v42, v22, v26, vcc
    v_cndmask_b32 v46, v38, v54, vcc
    v_cndmask_b32 v43, v23, v27, vcc
    v_cndmask_b32 v47, v39, v55, vcc
    v_sub_f32 v12, v12, v40
    v_mul_f32 v12, s61, v12
    v_exp_f32 v12, v12
    v_sub_f32 v13, v13, v41
    v_mul_f32 v13, s61, v13
    v_exp_f32 v13, v13
    v_sub_f32 v14, v14, v42
    v_mul_f32 v14, s61, v14
    v_exp_f32 v14, v14
    v_sub_f32 v15, v15, v43
    v_mul_f32 v15, s61, v15
    v_exp_f32 v15, v15
    s_nop 0
    v_fma_f32 v28, v28, v44, v12
    v_cvt_pk_bf16_f32 v40, v12, v12
    v_fma_f32 v29, v29, v45, v13
    v_cvt_pk_bf16_f32 v41, v13, v13
    v_fma_f32 v30, v30, v46, v14
    v_cvt_pk_bf16_f32 v42, v14, v14
    v_fma_f32 v31, v31, v47, v15
    v_cvt_pk_bf16_f32 v43, v15, v15
    ds_write_b16 v17, v40 offset:0
    ds_write_b16 v17, v41 offset:144
    ds_write_b16 v17, v42 offset:288
    ds_write_b16 v17, v43 offset:432
    v_mul_f32 v224, v36, v224
    v_mul_f32 v225, v37, v225
    v_mul_f32 v226, v38, v226
    v_mul_f32 v227, v39, v227
    v_mul_f32 v228, v36, v228
    v_mul_f32 v229, v37, v229
    v_mul_f32 v230, v38, v230
    v_mul_f32 v231, v39, v231
    v_mul_f32 v232, v36, v232
    v_mul_f32 v233, v37, v233
    v_mul_f32 v234, v38, v234
    v_mul_f32 v235, v39, v235
    v_mul_f32 v236, v36, v236
    v_mul_f32 v237, v37, v237
    v_mul_f32 v238, v38, v238
    v_mul_f32 v239, v39, v239
    v_mul_f32 v240, v52, v240
    v_mul_f32 v241, v53, v241
    v_mul_f32 v242, v54, v242
    v_mul_f32 v243, v55, v243
    v_mul_f32 v244, v52, v244
    v_mul_f32 v245, v53, v245
    v_mul_f32 v246, v54, v246
    v_mul_f32 v247, v55, v247
    v_mul_f32 v248, v52, v248
    v_mul_f32 v249, v53, v249
    v_mul_f32 v250, v54, v250
    v_mul_f32 v251, v55, v251
    v_mul_f32 v252, v52, v252
    v_mul_f32 v253, v53, v253
    v_mul_f32 v254, v54, v254
    v_mul_f32 v255, v55, v255
    s_waitcnt lgkmcnt(0)
    s_barrier
    ds_read_b128 v[32:35], v18 offset:0
    ds_read_b128 v[36:39], v18 offset:64
    ds_read_b128 v[40:43], v18 offset:2304
    ds_read_b128 v[44:47], v18 offset:2368
    ds_read_b64_tr_b16 v[48:49], v19 offset:0
    ds_read_b64_tr_b16 v[50:51], v19 offset:4160
    ds_read_b64_tr_b16 v[52:53], v19 offset:33280
    ds_read_b64_tr_b16 v[54:55], v19 offset:37440
    ds_read_b64_tr_b16 v[56:57], v19 offset:32
    ds_read_b64_tr_b16 v[58:59], v19 offset:4192
    ds_read_b64_tr_b16 v[60:61], v19 offset:33312
    ds_read_b64_tr_b16 v[62:63], v19 offset:37472
    s_waitcnt lgkmcnt(4)
    v_mfma_f32_16x16x32_bf16 v[224:227], v[32:35], v[48:51], v[224:227]
    v_mfma_f32_16x16x32_bf16 v[240:243], v[40:43], v[48:51], v[240:243]
    v_mfma_f32_16x16x32_bf16 v[224:227], v[36:39], v[52:55], v[224:227]
    v_mfma_f32_16x16x32_bf16 v[240:243], v[44:47], v[52:55], v[240:243]
    s_waitcnt lgkmcnt(0)
    v_mfma_f32_16x16x32_bf16 v[228:231], v[32:35], v[56:59], v[228:231]
    v_mfma_f32_16x16x32_bf16 v[244:247], v[40:43], v[56:59], v[244:247]
    v_mfma_f32_16x16x32_bf16 v[228:231], v[36:39], v[60:63], v[228:231]
    v_mfma_f32_16x16x32_bf16 v[244:247], v[44:47], v[60:63], v[244:247]
    s_nop 3
    ds_read_b64_tr_b16 v[48:49], v19 offset:64
    ds_read_b64_tr_b16 v[50:51], v19 offset:4224
    ds_read_b64_tr_b16 v[52:53], v19 offset:33344
    ds_read_b64_tr_b16 v[54:55], v19 offset:37504
    ds_read_b64_tr_b16 v[56:57], v19 offset:96
    ds_read_b64_tr_b16 v[58:59], v19 offset:4256
    ds_read_b64_tr_b16 v[60:61], v19 offset:33376
    ds_read_b64_tr_b16 v[62:63], v19 offset:37536
    s_waitcnt lgkmcnt(4)
    v_mfma_f32_16x16x32_bf16 v[232:235], v[32:35], v[48:51], v[232:235]
    v_mfma_f32_16x16x32_bf16 v[248:251], v[40:43], v[48:51], v[248:251]
    v_mfma_f32_16x16x32_bf16 v[232:235], v[36:39], v[52:55], v[232:235]
    v_mfma_f32_16x16x32_bf16 v[248:251], v[44:47], v[52:55], v[248:251]
    s_waitcnt lgkmcnt(0)
    v_mfma_f32_16x16x32_bf16 v[236:239], v[32:35], v[56:59], v[236:239]
    v_mfma_f32_16x16x32_bf16 v[252:255], v[40:43], v[56:59], v[252:255]
    v_mfma_f32_16x16x32_bf16 v[236:239], v[36:39], v[60:63], v[236:239]
    v_mfma_f32_16x16x32_bf16 v[252:255], v[44:47], v[60:63], v[252:255]
    s_nop 3
    s_nop 7
    s_nop 3
    s_nop 1
    v_add_f32_dpp v28, v28, v28 row_ror:8 row_mask:0xf bank_mask:0xf
    v_add_f32_dpp v29, v29, v29 row_ror:8 row_mask:0xf bank_mask:0xf
    v_add_f32_dpp v30, v30, v30 row_ror:8 row_mask:0xf bank_mask:0xf
    v_add_f32_dpp v31, v31, v31 row_ror:8 row_mask:0xf bank_mask:0xf
    s_nop 1
    v_add_f32_dpp v28, v28, v28 row_ror:4 row_mask:0xf bank_mask:0xf
    v_add_f32_dpp v29, v29, v29 row_ror:4 row_mask:0xf bank_mask:0xf
    v_add_f32_dpp v30, v30, v30 row_ror:4 row_mask:0xf bank_mask:0xf
    v_add_f32_dpp v31, v31, v31 row_ror:4 row_mask:0xf bank_mask:0xf
    s_nop 1
    v_add_f32_dpp v28, v28, v28 row_ror:2 row_mask:0xf bank_mask:0xf
    v_add_f32_dpp v29, v29, v29 row_ror:2 row_mask:0xf bank_mask:0xf
    v_add_f32_dpp v30, v30, v30 row_ror:2 row_mask:0xf bank_mask:0xf
    v_add_f32_dpp v31, v31, v31 row_ror:2 row_mask:0xf bank_mask:0xf
    s_nop 1
    v_add_f32_dpp v28, v28, v28 row_ror:1 row_mask:0xf bank_mask:0xf
    v_add_f32_dpp v29, v29, v29 row_ror:1 row_mask:0xf bank_mask:0xf
    v_add_f32_dpp v30, v30, v30 row_ror:1 row_mask:0xf bank_mask:0xf
    v_add_f32_dpp v31, v31, v31 row_ror:1 row_mask:0xf bank_mask:0xf
    s_nop 1
    ds_write_b128 v11, v[28:31] offset:5120
    s_lshr_b32 s55, s96, 5
    s_lshl_b32 s55, s55, 20
    s_and_b32 s58, s96, 31
    s_lshl_b32 s58, s58, 10
    s_add_u32 s55, s55, s58
    s_add_u32 s55, s55, 393216
    s_barrier
    v_mul_u32_u24 v32, 8256, v3
    v_lshl_add_u32 v32, v1, 8, v32
    v_lshl_add_u32 v32, v4, 2, v32
    v_add_u32 v32, 38912, v32
    ds_write_b32 v32, v224 offset:0
    ds_write_b32 v32, v228 offset:64
    ds_write_b32 v32, v232 offset:128
    ds_write_b32 v32, v236 offset:192
    ds_write_b32 v32, v225 offset:2064
    ds_write_b32 v32, v229 offset:2128
    ds_write_b32 v32, v233 offset:2192
    ds_write_b32 v32, v237 offset:2256
    ds_write_b32 v32, v226 offset:4128
    ds_write_b32 v32, v230 offset:4192
    ds_write_b32 v32, v234 offset:4256
    ds_write_b32 v32, v238 offset:4320
    ds_write_b32 v32, v227 offset:6192
    ds_write_b32 v32, v231 offset:6256
    ds_write_b32 v32, v235 offset:6320
    ds_write_b32 v32, v239 offset:6384
    ds_write_b32 v32, v240 offset:33024
    ds_write_b32 v32, v244 offset:33088
    ds_write_b32 v32, v248 offset:33152
    ds_write_b32 v32, v252 offset:33216
    ds_write_b32 v32, v241 offset:35088
    ds_write_b32 v32, v245 offset:35152
    ds_write_b32 v32, v249 offset:35216
    ds_write_b32 v32, v253 offset:35280
    ds_write_b32 v32, v242 offset:37152
    ds_write_b32 v32, v246 offset:37216
    ds_write_b32 v32, v250 offset:37280
    ds_write_b32 v32, v254 offset:37344
    ds_write_b32 v32, v243 offset:39216
    ds_write_b32 v32, v247 offset:39280
    ds_write_b32 v32, v251 offset:39344
    ds_write_b32 v32, v255 offset:39408
    s_waitcnt lgkmcnt(0)
    s_barrier
    v_mul_u32_u24 v35, 2064, v1
    v_lshl_add_u32 v35, v2, 5, v35
    v_add_u32 v35, 38912, v35
    v_lshlrev_b32 v36, 15, v1
    v_lshl_add_u32 v36, v2, 4, v36
    ds_read_b128 v[64:67], v35 offset:0
    ds_read_b128 v[68:71], v35 offset:16
    ds_read_b128 v[72:75], v35 offset:16512
    ds_read_b128 v[76:79], v35 offset:16528
    ds_read_b128 v[80:83], v35 offset:33024
    ds_read_b128 v[84:87], v35 offset:33040
    ds_read_b128 v[88:91], v35 offset:49536
    ds_read_b128 v[92:95], v35 offset:49552
    s_waitcnt lgkmcnt(6)
    v_cvt_pk_bf16_f32 v96, v64, v65
    v_cvt_pk_bf16_f32 v97, v66, v67
    v_cvt_pk_bf16_f32 v98, v68, v69
    v_cvt_pk_bf16_f32 v99, v70, v71
    s_add_u32 s58, s55, 0
    buffer_store_dwordx4 v[96:99], v36, s[32:35], s58 offen sc1
    s_waitcnt lgkmcnt(4)
    v_cvt_pk_bf16_f32 v100, v72, v73
    v_cvt_pk_bf16_f32 v101, v74, v75
    v_cvt_pk_bf16_f32 v102, v76, v77
    v_cvt_pk_bf16_f32 v103, v78, v79
    s_add_u32 s58, s55, 262144
    buffer_store_dwordx4 v[100:103], v36, s[32:35], s58 offen sc1
    s_waitcnt lgkmcnt(2)
    v_cvt_pk_bf16_f32 v104, v80, v81
    v_cvt_pk_bf16_f32 v105, v82, v83
    v_cvt_pk_bf16_f32 v106, v84, v85
    v_cvt_pk_bf16_f32 v107, v86, v87
    s_add_u32 s58, s55, 524288
    buffer_store_dwordx4 v[104:107], v36, s[32:35], s58 offen sc1
    s_waitcnt lgkmcnt(0)
    v_cvt_pk_bf16_f32 v108, v88, v89
    v_cvt_pk_bf16_f32 v109, v90, v91
    v_cvt_pk_bf16_f32 v110, v92, v93
    v_cvt_pk_bf16_f32 v111, v94, v95
    s_add_u32 s58, s55, 786432
    buffer_store_dwordx4 v[108:111], v36, s[32:35], s58 offen sc1
    s_cmp_ge_u32 s60, 2
    s_cbranch_scc1 BSK_22
    v_lshlrev_b32 v33, 6, v7
    v_lshl_add_u32 v33, v3, 4, v33
    ds_read_b128 v[40:43], v33 offset:5120
    ds_read_b128 v[44:47], v33 offset:5248
    ds_read_b128 v[48:51], v33 offset:5376
    ds_read_b128 v[52:55], v33 offset:5504
    s_waitcnt lgkmcnt(0)
    s_lshr_b32 s55, s96, 5
    s_lshl_b32 s55, s55, 13
    s_and_b32 s58, s96, 31
    s_lshl_b32 s58, s58, 3
    s_add_u32 s55, s55, s58
    s_add_u32 s55, s55, 368640
    v_lshl_add_u32 v34, v7, 2, v3
    v_lshlrev_b32 v34, 10, v34
    v_cmp_eq_u32 s[66:67], 0, v4
    v_cmp_eq_u32 vcc, 1, v7
    s_nop 1
    v_cndmask_b32 v36, v20, v24, vcc
    v_mul_f32 v36, s61, v36
    v_add_f32 v37, v40, v44
    v_add_f32 v38, v48, v52
    v_add_f32 v37, v37, v38
    s_mov_b64 s[62:63], exec
    s_and_b64 exec, exec, s[66:67]
    buffer_store_dwordx2 v[36:37], v34, s[32:35], s55 offen offset:0 sc1
    s_nop 1
    s_mov_b64 exec, s[62:63]
    v_cmp_eq_u32 vcc, 1, v7
    s_nop 1
    v_cndmask_b32 v36, v21, v25, vcc
    v_mul_f32 v36, s61, v36
    v_add_f32 v37, v41, v45
    v_add_f32 v38, v49, v53
    v_add_f32 v37, v37, v38
    s_mov_b64 s[62:63], exec
    s_and_b64 exec, exec, s[66:67]
    buffer_store_dwordx2 v[36:37], v34, s[32:35], s55 offen offset:256 sc1
    s_nop 1
    s_mov_b64 exec, s[62:63]
    v_cmp_eq_u32 vcc, 1, v7
    s_nop 1
    v_cndmask_b32 v36, v22, v26, vcc
    v_mul_f32 v36, s61, v36
    v_add_f32 v37, v42, v46
    v_add_f32 v38, v50, v54
    v_add_f32 v37, v37, v38
    s_mov_b64 s[62:63], exec
    s_and_b64 exec, exec, s[66:67]
    buffer_store_dwordx2 v[36:37], v34, s[32:35], s55 offen offset:512 sc1
    s_nop 1
    s_mov_b64 exec, s[62:63]
    v_cmp_eq_u32 vcc, 1, v7
    s_nop 1
    v_cndmask_b32 v36, v23, v27, vcc
    v_mul_f32 v36, s61, v36
    v_add_f32 v37, v43, v47
    v_add_f32 v38, v51, v55
    v_add_f32 v37, v37, v38
    s_mov_b64 s[62:63], exec
    s_and_b64 exec, exec, s[66:67]
    buffer_store_dwordx2 v[36:37], v34, s[32:35], s55 offen offset:768 sc1
    s_nop 1
    s_mov_b64 exec, s[62:63]
BSK_22:
    s_waitcnt vmcnt(0)
    s_barrier
    s_cmp_lg_u32 s60, 0
    s_cbranch_scc1 W0E_23
    s_mov_b32 s55, 224
    s_mov_b64 s[62:63], exec
    s_mov_b64 exec, 1
    v_mov_b32 v5, 1
    v_mov_b32 v6, s55
    v_lshlrev_b32 v6, 5, v6
    v_add_u32 v6, 7864320, v6
    buffer_atomic_add v5, v6, s[32:35], 0 offen
    s_mov_b64 exec, s[62:63]
W0E_23:
    s_mov_b32 s55, 29826162
    v_mul_hi_u32 v92, v0, s55
    v_mul_u32_u24 v93, 144, v92
    v_sub_u32 v93, v0, v93
    v_mul_u32_u24 v5, 1152, v92
    v_lshl_add_u32 v5, v93, 3, v5
    v_cmp_gt_u32 vcc, 0x1b0, v0
    v_mov_b32 v6, 0x7fffff00
    s_nop 1
    v_cndmask_b32 v5, v6, v5, vcc
    s_mul_i32 s55, s3, 36864
    buffer_load_dwordx2 v[16:17], v5, s[40:43], s55 offen nt
    s_add_u32 s55, s55, 3456
    buffer_load_dwordx2 v[18:19], v5, s[40:43], s55 offen nt
    s_add_u32 s55, s55, 3456
    buffer_load_dwordx2 v[20:21], v5, s[40:43], s55 offen nt
    s_add_u32 s55, s55, 3456
    buffer_load_dwordx2 v[22:23], v5, s[40:43], s55 offen nt
    s_add_u32 s55, s55, 3456
    buffer_load_dwordx2 v[24:25], v5, s[40:43], s55 offen nt
    s_add_u32 s55, s55, 3456
    buffer_load_dwordx2 v[26:27], v5, s[40:43], s55 offen nt
    s_add_u32 s55, s55, 3456
    buffer_load_dwordx2 v[28:29], v5, s[40:43], s55 offen nt
    s_add_u32 s55, s55, 3456
    buffer_load_dwordx2 v[30:31], v5, s[40:43], s55 offen nt
    s_add_u32 s55, s55, 3456
    buffer_load_dwordx2 v[32:33], v5, s[40:43], s55 offen nt
    s_add_u32 s55, s55, 3456
    buffer_load_dwordx2 v[34:35], v5, s[40:43], s55 offen nt
    s_add_u32 s55, s55, 3456
    buffer_load_dwordx2 v[36:37], v5, s[40:43], s55 offen nt
    s_add_u32 s55, s55, 3456
    v_lshrrev_b32 v5, 2, v0
    v_lshlrev_b32 v5, 13, v5
    v_and_b32 v6, 3, v0
    v_lshl_add_u32 v5, v6, 4, v5
    s_cmp_lt_u32 s2, 128
    s_cselect_b32 s55, 0x7fffff00, 0
    v_add_u32 v5, s55, v5
    s_lshl_b32 s55, s3, 6
    buffer_load_dwordx4 v[40:43], v5, s[44:47], s55 offen nt
    s_add_u32 s55, s55, 1048576
    buffer_load_dwordx4 v[44:47], v5, s[44:47], s55 offen nt
    s_add_u32 s55, s55, 1048576
    buffer_load_dwordx4 v[48:51], v5, s[44:47], s55 offen nt
    s_add_u32 s55, s55, 1048576
    buffer_load_dwordx4 v[52:55], v5, s[44:47], s55 offen nt
    s_add_u32 s55, s55, 1048576
P3:
    s_lshr_b32 s56, s3, 2
    s_and_b32 s57, s3, 3
    s_cmp_ge_u32 s2, 128
    s_cbranch_scc1 P3B
    s_cmp_lg_u32 s60, 0
    s_cbranch_scc1 W0E_24
    s_lshr_b32 s55, s56, 1
    s_lshl_b32 s55, s55, 2
    s_mov_b64 s[62:63], exec
    s_mov_b64 exec, 1
    v_lshlrev_b32 v6, 2, v2
    v_add_u32 v6, s55, v6
    v_lshlrev_b32 v6, 5, v6
    v_add_u32 v6, 7864320, v6
    s_mov_b32 s64, 0
POLL_25:
    buffer_load_dword v5, v6, s[32:35], 0 offen sc1
    s_waitcnt vmcnt(0)
    v_cmp_le_u32 vcc, 20, v5
    s_nop 3
    s_cmp_eq_u64 vcc, exec
    s_cbranch_scc1 PDONE_26
    s_add_u32 s64, s64, 1
    s_cmp_gt_u32 s64, 0x20000
    s_cbranch_scc1 PDONE_26
    s_sleep 2
    s_branch POLL_25
PDONE_26:
    s_mov_b64 exec, s[62:63]
    v_lshrrev_b32 v5, 5, v0
    v_and_b32 v6, 31, v0
    s_mul_i32 s55, s56, 3168
    s_add_u32 s55, s55, 98304
    s_mov_b32 s58, 101376
    v_mul_lo_u32 v7, v5, s58
    s_lshl_b32 s58, s57, 7
    v_lshl_add_u32 v8, v6, 2, v7
    v_add_u32 v8, s58, v8
    v_add_u32 v7, 0x200, v7
    buffer_load_dword v96, v8, s[32:35], s55 offen offset:0 sc1
    buffer_load_dwordx2 v[104:105], v7, s[32:35], s55 offen offset:0 sc1
    buffer_load_dword v97, v8, s[32:35], s55 offen offset:528 sc1
    buffer_load_dwordx2 v[106:107], v7, s[32:35], s55 offen offset:528 sc1
    buffer_load_dword v98, v8, s[32:35], s55 offen offset:1056 sc1
    buffer_load_dwordx2 v[108:109], v7, s[32:35], s55 offen offset:1056 sc1
    buffer_load_dword v99, v8, s[32:35], s55 offen offset:1584 sc1
    buffer_load_dwordx2 v[110:111], v7, s[32:35], s55 offen offset:1584 sc1
    buffer_load_dword v100, v8, s[32:35], s55 offen offset:2112 sc1
    buffer_load_dwordx2 v[112:113], v7, s[32:35], s55 offen offset:2112 sc1
    buffer_load_dword v101, v8, s[32:35], s55 offen offset:2640 sc1
    buffer_load_dwordx2 v[114:115], v7, s[32:35], s55 offen offset:2640 sc1
    s_waitcnt vmcnt(0)
    v_max_f32 v9, v104, v106
    v_max_f32 v9, v9, v108
    v_max_f32 v9, v9, v110
    v_max_f32 v9, v9, v112
    v_max_f32 v9, v9, v114
    v_mov_b32 v10, 0
    v_mov_b32 v11, 0
    v_sub_f32 v12, v104, v9
    v_exp_f32 v12, v12
    s_nop 0
    v_fmac_f32 v10, v12, v96
    v_fmac_f32 v11, v12, v105
    v_sub_f32 v12, v106, v9
    v_exp_f32 v12, v12
    s_nop 0
    v_fmac_f32 v10, v12, v97
    v_fmac_f32 v11, v12, v107
    v_sub_f32 v12, v108, v9
    v_exp_f32 v12, v12
    s_nop 0
    v_fmac_f32 v10, v12, v98
    v_fmac_f32 v11, v12, v109
    v_sub_f32 v12, v110, v9
    v_exp_f32 v12, v12
    s_nop 0
    v_fmac_f32 v10, v12, v99
    v_fmac_f32 v11, v12, v111
    v_sub_f32 v12, v112, v9
    v_exp_f32 v12, v12
    s_nop 0
    v_fmac_f32 v10, v12, v100
    v_fmac_f32 v11, v12, v113
    v_sub_f32 v12, v114, v9
    v_exp_f32 v12, v12
    s_nop 0
    v_fmac_f32 v10, v12, v101
    v_fmac_f32 v11, v12, v115
    v_rcp_f32 v11, v11
    s_nop 0
    v_mul_f32 v10, v10, v11
    v_cvt_pk_bf16_f32 v10, v10, v10
    v_lshlrev_b32 v10, 16, v10
    v_mul_u32_u24 v12, 144, v5
    v_lshl_add_u32 v12, v6, 2, v12
    ds_write_b32 v12, v10
    v_mov_b32 v13, 0
    v_mul_u32_u24 v12, 144, v5
    ds_write_b32 v12, v13 offset:128
    s_waitcnt lgkmcnt(0)
W0E_24:
    s_branch P3OUT
P3B:
    s_cmp_lg_u32 s60, 0
    s_cbranch_scc1 W0E_27
    s_mov_b32 s55, 224
    s_mov_b64 s[62:63], exec
    s_mov_b64 exec, 1
    v_lshlrev_b32 v6, 2, v2
    v_add_u32 v6, s55, v6
    v_lshlrev_b32 v6, 5, v6
    v_add_u32 v6, 7864320, v6
    s_mov_b32 s64, 0
POLL_28:
    buffer_load_dword v5, v6, s[32:35], 0 offen sc1
    s_waitcnt vmcnt(0)
    v_cmp_le_u32 vcc, 64, v5
    s_nop 3
    s_cmp_eq_u64 vcc, exec
    s_cbranch_scc1 PDONE_29
    s_add_u32 s64, s64, 1
    s_cmp_gt_u32 s64, 0x20000
    s_cbranch_scc1 PDONE_29
    s_sleep 2
    s_branch POLL_28
PDONE_29:
    s_mov_b64 exec, s[62:63]
W0E_27:
    s_barrier
    s_lshl_b32 s55, s56, 8
    s_add_u32 s55, s55, 368640
    v_lshrrev_b32 v7, 5, v2
    v_lshlrev_b32 v5, 13, v7
    v_and_b32 v7, 31, v2
    v_lshl_add_u32 v5, v7, 3, v5
    buffer_load_dwordx2 v[160:161], v5, s[32:35], s55 offen sc1
    v_lshrrev_b32 v8, 8, v0
    v_and_b32 v9, 255, v0
    v_lshlrev_b32 v5, 20, v8
    v_lshl_add_u32 v5, v9, 2, v5
    s_lshl_b32 s55, s56, 15
    s_add_u32 s55, s55, 393216
    buffer_load_dword v96, v5, s[32:35], s55 offen offset:0 sc1
    buffer_load_dword v97, v5, s[32:35], s55 offen offset:1024 sc1
    buffer_load_dword v98, v5, s[32:35], s55 offen offset:2048 sc1
    buffer_load_dword v99, v5, s[32:35], s55 offen offset:3072 sc1
    s_add_u32 s55, s55, 4096
    buffer_load_dword v100, v5, s[32:35], s55 offen offset:0 sc1
    buffer_load_dword v101, v5, s[32:35], s55 offen offset:1024 sc1
    buffer_load_dword v102, v5, s[32:35], s55 offen offset:2048 sc1
    buffer_load_dword v103, v5, s[32:35], s55 offen offset:3072 sc1
    s_add_u32 s55, s55, 4096
    buffer_load_dword v104, v5, s[32:35], s55 offen offset:0 sc1
    buffer_load_dword v105, v5, s[32:35], s55 offen offset:1024 sc1
    buffer_load_dword v106, v5, s[32:35], s55 offen offset:2048 sc1
    buffer_load_dword v107, v5, s[32:35], s55 offen offset:3072 sc1
    s_add_u32 s55, s55, 4096
    buffer_load_dword v108, v5, s[32:35], s55 offen offset:0 sc1
    buffer_load_dword v109, v5, s[32:35], s55 offen offset:1024 sc1
    buffer_load_dword v110, v5, s[32:35], s55 offen offset:2048 sc1
    buffer_load_dword v111, v5, s[32:35], s55 offen offset:3072 sc1
    s_add_u32 s55, s55, 4096
    buffer_load_dword v112, v5, s[32:35], s55 offen offset:0 sc1
    buffer_load_dword v113, v5, s[32:35], s55 offen offset:1024 sc1
    buffer_load_dword v114, v5, s[32:35], s55 offen offset:2048 sc1
    buffer_load_dword v115, v5, s[32:35], s55 offen offset:3072 sc1
    s_add_u32 s55, s55, 4096
    buffer_load_dword v116, v5, s[32:35], s55 offen offset:0 sc1
    buffer_load_dword v117, v5, s[32:35], s55 offen offset:1024 sc1
    buffer_load_dword v118, v5, s[32:35], s55 offen offset:2048 sc1
    buffer_load_dword v119, v5, s[32:35], s55 offen offset:3072 sc1
    s_add_u32 s55, s55, 4096
    buffer_load_dword v120, v5, s[32:35], s55 offen offset:0 sc1
    buffer_load_dword v121, v5, s[32:35], s55 offen offset:1024 sc1
    buffer_load_dword v122, v5, s[32:35], s55 offen offset:2048 sc1
    buffer_load_dword v123, v5, s[32:35], s55 offen offset:3072 sc1
    s_add_u32 s55, s55, 4096
    buffer_load_dword v124, v5, s[32:35], s55 offen offset:0 sc1
    buffer_load_dword v125, v5, s[32:35], s55 offen offset:1024 sc1
    buffer_load_dword v126, v5, s[32:35], s55 offen offset:2048 sc1
    buffer_load_dword v127, v5, s[32:35], s55 offen offset:3072 sc1
    s_add_u32 s55, s55, 4096
    s_waitcnt vmcnt(32)
    v_mov_b32 v162, v160
    s_nop 1
    v_max_f32_dpp v162, v162, v162 row_ror:8 row_mask:0xf bank_mask:0xf
    s_nop 1
    v_max_f32_dpp v162, v162, v162 row_ror:4 row_mask:0xf bank_mask:0xf
    s_nop 1
    v_max_f32_dpp v162, v162, v162 row_ror:2 row_mask:0xf bank_mask:0xf
    s_nop 1
    v_max_f32_dpp v162, v162, v162 row_ror:1 row_mask:0xf bank_mask:0xf
    s_nop 1
    ds_swizzle_b32 v163, v162 offset:0x401F
    s_waitcnt lgkmcnt(0)
    v_max_f32 v162, v162, v163
    v_sub_f32 v160, v160, v162
    v_exp_f32 v160, v160
    s_nop 0
    v_mul_f32 v161, v160, v161
    s_nop 1
    v_add_f32_dpp v161, v161, v161 row_ror:8 row_mask:0xf bank_mask:0xf
    s_nop 1
    v_add_f32_dpp v161, v161, v161 row_ror:4 row_mask:0xf bank_mask:0xf
    s_nop 1
    v_add_f32_dpp v161, v161, v161 row_ror:2 row_mask:0xf bank_mask:0xf
    s_nop 1
    v_add_f32_dpp v161, v161, v161 row_ror:1 row_mask:0xf bank_mask:0xf
    s_nop 1
    ds_swizzle_b32 v163, v161 offset:0x401F
    s_waitcnt lgkmcnt(0)
    v_add_f32 v161, v161, v163
    v_rcp_f32 v161, v161
    s_nop 0
    v_mul_f32 v160, v160, v161
    v_lshlrev_b32 v7, 2, v2
    v_lshl_add_u32 v7, v1, 8, v7
    ds_write_b32 v7, v160 offset:36864
    s_waitcnt lgkmcnt(0)
    v_lshlrev_b32 v6, 8, v1
    v_lshl_add_u32 v6, v8, 7, v6
    ds_read_b128 v[164:167], v6 offset:36864
    ds_read_b128 v[168:171], v6 offset:36880
    ds_read_b128 v[172:175], v6 offset:36896
    ds_read_b128 v[176:179], v6 offset:36912
    ds_read_b128 v[180:183], v6 offset:36928
    ds_read_b128 v[184:187], v6 offset:36944
    ds_read_b128 v[188:191], v6 offset:36960
    ds_read_b128 v[192:195], v6 offset:36976
    v_mov_b32 v10, 0
    v_mov_b32 v11, 0
    s_waitcnt vmcnt(0) lgkmcnt(0)
    v_lshlrev_b32 v12, 16, v96
    v_and_b32 v13, 0xffff0000, v96
    v_fmac_f32 v10, v164, v12
    v_fmac_f32 v11, v164, v13
    v_lshlrev_b32 v12, 16, v97
    v_and_b32 v13, 0xffff0000, v97
    v_fmac_f32 v10, v165, v12
    v_fmac_f32 v11, v165, v13
    v_lshlrev_b32 v12, 16, v98
    v_and_b32 v13, 0xffff0000, v98
    v_fmac_f32 v10, v166, v12
    v_fmac_f32 v11, v166, v13
    v_lshlrev_b32 v12, 16, v99
    v_and_b32 v13, 0xffff0000, v99
    v_fmac_f32 v10, v167, v12
    v_fmac_f32 v11, v167, v13
    v_lshlrev_b32 v12, 16, v100
    v_and_b32 v13, 0xffff0000, v100
    v_fmac_f32 v10, v168, v12
    v_fmac_f32 v11, v168, v13
    v_lshlrev_b32 v12, 16, v101
    v_and_b32 v13, 0xffff0000, v101
    v_fmac_f32 v10, v169, v12
    v_fmac_f32 v11, v169, v13
    v_lshlrev_b32 v12, 16, v102
    v_and_b32 v13, 0xffff0000, v102
    v_fmac_f32 v10, v170, v12
    v_fmac_f32 v11, v170, v13
    v_lshlrev_b32 v12, 16, v103
    v_and_b32 v13, 0xffff0000, v103
    v_fmac_f32 v10, v171, v12
    v_fmac_f32 v11, v171, v13
    v_lshlrev_b32 v12, 16, v104
    v_and_b32 v13, 0xffff0000, v104
    v_fmac_f32 v10, v172, v12
    v_fmac_f32 v11, v172, v13
    v_lshlrev_b32 v12, 16, v105
    v_and_b32 v13, 0xffff0000, v105
    v_fmac_f32 v10, v173, v12
    v_fmac_f32 v11, v173, v13
    v_lshlrev_b32 v12, 16, v106
    v_and_b32 v13, 0xffff0000, v106
    v_fmac_f32 v10, v174, v12
    v_fmac_f32 v11, v174, v13
    v_lshlrev_b32 v12, 16, v107
    v_and_b32 v13, 0xffff0000, v107
    v_fmac_f32 v10, v175, v12
    v_fmac_f32 v11, v175, v13
    v_lshlrev_b32 v12, 16, v108
    v_and_b32 v13, 0xffff0000, v108
    v_fmac_f32 v10, v176, v12
    v_fmac_f32 v11, v176, v13
    v_lshlrev_b32 v12, 16, v109
    v_and_b32 v13, 0xffff0000, v109
    v_fmac_f32 v10, v177, v12
    v_fmac_f32 v11, v177, v13
    v_lshlrev_b32 v12, 16, v110
    v_and_b32 v13, 0xffff0000, v110
    v_fmac_f32 v10, v178, v12
    v_fmac_f32 v11, v178, v13
    v_lshlrev_b32 v12, 16, v111
    v_and_b32 v13, 0xffff0000, v111
    v_fmac_f32 v10, v179, v12
    v_fmac_f32 v11, v179, v13
    v_lshlrev_b32 v12, 16, v112
    v_and_b32 v13, 0xffff0000, v112
    v_fmac_f32 v10, v180, v12
    v_fmac_f32 v11, v180, v13
    v_lshlrev_b32 v12, 16, v113
    v_and_b32 v13, 0xffff0000, v113
    v_fmac_f32 v10, v181, v12
    v_fmac_f32 v11, v181, v13
    v_lshlrev_b32 v12, 16, v114
    v_and_b32 v13, 0xffff0000, v114
    v_fmac_f32 v10, v182, v12
    v_fmac_f32 v11, v182, v13
    v_lshlrev_b32 v12, 16, v115
    v_and_b32 v13, 0xffff0000, v115
    v_fmac_f32 v10, v183, v12
    v_fmac_f32 v11, v183, v13
    v_lshlrev_b32 v12, 16, v116
    v_and_b32 v13, 0xffff0000, v116
    v_fmac_f32 v10, v184, v12
    v_fmac_f32 v11, v184, v13
    v_lshlrev_b32 v12, 16, v117
    v_and_b32 v13, 0xffff0000, v117
    v_fmac_f32 v10, v185, v12
    v_fmac_f32 v11, v185, v13
    v_lshlrev_b32 v12, 16, v118
    v_and_b32 v13, 0xffff0000, v118
    v_fmac_f32 v10, v186, v12
    v_fmac_f32 v11, v186, v13
    v_lshlrev_b32 v12, 16, v119
    v_and_b32 v13, 0xffff0000, v119
    v_fmac_f32 v10, v187, v12
    v_fmac_f32 v11, v187, v13
    v_lshlrev_b32 v12, 16, v120
    v_and_b32 v13, 0xffff0000, v120
    v_fmac_f32 v10, v188, v12
    v_fmac_f32 v11, v188, v13
    v_lshlrev_b32 v12, 16, v121
    v_and_b32 v13, 0xffff0000, v121
    v_fmac_f32 v10, v189, v12
    v_fmac_f32 v11, v189, v13
    v_lshlrev_b32 v12, 16, v122
    v_and_b32 v13, 0xffff0000, v122
    v_fmac_f32 v10, v190, v12
    v_fmac_f32 v11, v190, v13
    v_lshlrev_b32 v12, 16, v123
    v_and_b32 v13, 0xffff0000, v123
    v_fmac_f32 v10, v191, v12
    v_fmac_f32 v11, v191, v13
    v_lshlrev_b32 v12, 16, v124
    v_and_b32 v13, 0xffff0000, v124
    v_fmac_f32 v10, v192, v12
    v_fmac_f32 v11, v192, v13
    v_lshlrev_b32 v12, 16, v125
    v_and_b32 v13, 0xffff0000, v125
    v_fmac_f32 v10, v193, v12
    v_fmac_f32 v11, v193, v13
    v_lshlrev_b32 v12, 16, v126
    v_and_b32 v13, 0xffff0000, v126
    v_fmac_f32 v10, v194, v12
    v_fmac_f32 v11, v194, v13
    v_lshlrev_b32 v12, 16, v127
    v_and_b32 v13, 0xffff0000, v127
    v_fmac_f32 v10, v195, v12
    v_fmac_f32 v11, v195, v13
    v_lshlrev_b32 v5, 11, v8
    v_lshl_add_u32 v5, v9, 3, v5
    ds_write_b64 v5, v[10:11] offset:20736
    s_waitcnt lgkmcnt(0)
    s_barrier
    v_lshrrev_b32 v5, 2, v0
    v_lshlrev_b32 v5, 2, v5
    v_and_b32 v7, 3, v0
    ds_read_b32 v96, v5 offset:20736
    ds_read_b32 v97, v5 offset:22784
    ds_read_b32 v98, v5 offset:21248
    ds_read_b32 v99, v5 offset:23296
    ds_read_b32 v100, v5 offset:21760
    ds_read_b32 v101, v5 offset:23808
    ds_read_b32 v102, v5 offset:22272
    ds_read_b32 v103, v5 offset:24320
    v_mov_b32 v112, 0
    v_mov_b32 v113, 0
    v_mov_b32 v114, 0
    v_mov_b32 v115, 0
    v_mov_b32 v116, 0
    v_mov_b32 v117, 0
    v_mov_b32 v118, 0
    v_mov_b32 v119, 0
    v_mov_b32 v120, 0
    v_mov_b32 v121, 0
    v_mov_b32 v122, 0
    v_mov_b32 v123, 0
    v_mov_b32 v124, 0
    v_mov_b32 v125, 0
    v_mov_b32 v126, 0
    v_mov_b32 v127, 0
    s_waitcnt lgkmcnt(0)
    v_lshlrev_b32 v8, 16, v40
    v_and_b32 v9, 0xffff0000, v40
    v_fmac_f32 v112, v96, v8
    v_fmac_f32 v113, v96, v9
    v_fmac_f32 v120, v97, v8
    v_fmac_f32 v121, v97, v9
    v_lshlrev_b32 v8, 16, v41
    v_and_b32 v9, 0xffff0000, v41
    v_fmac_f32 v114, v96, v8
    v_fmac_f32 v115, v96, v9
    v_fmac_f32 v122, v97, v8
    v_fmac_f32 v123, v97, v9
    v_lshlrev_b32 v8, 16, v42
    v_and_b32 v9, 0xffff0000, v42
    v_fmac_f32 v116, v96, v8
    v_fmac_f32 v117, v96, v9
    v_fmac_f32 v124, v97, v8
    v_fmac_f32 v125, v97, v9
    v_lshlrev_b32 v8, 16, v43
    v_and_b32 v9, 0xffff0000, v43
    v_fmac_f32 v118, v96, v8
    v_fmac_f32 v119, v96, v9
    v_fmac_f32 v126, v97, v8
    v_fmac_f32 v127, v97, v9
    v_lshlrev_b32 v8, 16, v44
    v_and_b32 v9, 0xffff0000, v44
    v_fmac_f32 v112, v98, v8
    v_fmac_f32 v113, v98, v9
    v_fmac_f32 v120, v99, v8
    v_fmac_f32 v121, v99, v9
    v_lshlrev_b32 v8, 16, v45
    v_and_b32 v9, 0xffff0000, v45
    v_fmac_f32 v114, v98, v8
    v_fmac_f32 v115, v98, v9
    v_fmac_f32 v122, v99, v8
    v_fmac_f32 v123, v99, v9
    v_lshlrev_b32 v8, 16, v46
    v_and_b32 v9, 0xffff0000, v46
    v_fmac_f32 v116, v98, v8
    v_fmac_f32 v117, v98, v9
    v_fmac_f32 v124, v99, v8
    v_fmac_f32 v125, v99, v9
    v_lshlrev_b32 v8, 16, v47
    v_and_b32 v9, 0xffff0000, v47
    v_fmac_f32 v118, v98, v8
    v_fmac_f32 v119, v98, v9
    v_fmac_f32 v126, v99, v8
    v_fmac_f32 v127, v99, v9
    v_lshlrev_b32 v8, 16, v48
    v_and_b32 v9, 0xffff0000, v48
    v_fmac_f32 v112, v100, v8
    v_fmac_f32 v113, v100, v9
    v_fmac_f32 v120, v101, v8
    v_fmac_f32 v121, v101, v9
    v_lshlrev_b32 v8, 16, v49
    v_and_b32 v9, 0xffff0000, v49
    v_fmac_f32 v114, v100, v8
    v_fmac_f32 v115, v100, v9
    v_fmac_f32 v122, v101, v8
    v_fmac_f32 v123, v101, v9
    v_lshlrev_b32 v8, 16, v50
    v_and_b32 v9, 0xffff0000, v50
    v_fmac_f32 v116, v100, v8
    v_fmac_f32 v117, v100, v9
    v_fmac_f32 v124, v101, v8
    v_fmac_f32 v125, v101, v9
    v_lshlrev_b32 v8, 16, v51
    v_and_b32 v9, 0xffff0000, v51
    v_fmac_f32 v118, v100, v8
    v_fmac_f32 v119, v100, v9
    v_fmac_f32 v126, v101, v8
    v_fmac_f32 v127, v101, v9
    v_lshlrev_b32 v8, 16, v52
    v_and_b32 v9, 0xffff0000, v52
    v_fmac_f32 v112, v102, v8
    v_fmac_f32 v113, v102, v9
    v_fmac_f32 v120, v103, v8
    v_fmac_f32 v121, v103, v9
    v_lshlrev_b32 v8, 16, v53
    v_and_b32 v9, 0xffff0000, v53
    v_fmac_f32 v114, v102, v8
    v_fmac_f32 v115, v102, v9
    v_fmac_f32 v122, v103, v8
    v_fmac_f32 v123, v103, v9
    v_lshlrev_b32 v8, 16, v54
    v_and_b32 v9, 0xffff0000, v54
    v_fmac_f32 v116, v102, v8
    v_fmac_f32 v117, v102, v9
    v_fmac_f32 v124, v103, v8
    v_fmac_f32 v125, v103, v9
    v_lshlrev_b32 v8, 16, v55
    v_and_b32 v9, 0xffff0000, v55
    v_fmac_f32 v118, v102, v8
    v_fmac_f32 v119, v102, v9
    v_fmac_f32 v126, v103, v8
    v_fmac_f32 v127, v103, v9
    s_nop 1
    v_add_f32_dpp v112, v112, v112 row_ror:4 row_mask:0xf bank_mask:0xf
    v_add_f32_dpp v113, v113, v113 row_ror:4 row_mask:0xf bank_mask:0xf
    v_add_f32_dpp v114, v114, v114 row_ror:4 row_mask:0xf bank_mask:0xf
    v_add_f32_dpp v115, v115, v115 row_ror:4 row_mask:0xf bank_mask:0xf
    v_add_f32_dpp v116, v116, v116 row_ror:4 row_mask:0xf bank_mask:0xf
    v_add_f32_dpp v117, v117, v117 row_ror:4 row_mask:0xf bank_mask:0xf
    v_add_f32_dpp v118, v118, v118 row_ror:4 row_mask:0xf bank_mask:0xf
    v_add_f32_dpp v119, v119, v119 row_ror:4 row_mask:0xf bank_mask:0xf
    v_add_f32_dpp v120, v120, v120 row_ror:4 row_mask:0xf bank_mask:0xf
    v_add_f32_dpp v121, v121, v121 row_ror:4 row_mask:0xf bank_mask:0xf
    v_add_f32_dpp v122, v122, v122 row_ror:4 row_mask:0xf bank_mask:0xf
    v_add_f32_dpp v123, v123, v123 row_ror:4 row_mask:0xf bank_mask:0xf
    v_add_f32_dpp v124, v124, v124 row_ror:4 row_mask:0xf bank_mask:0xf
    v_add_f32_dpp v125, v125, v125 row_ror:4 row_mask:0xf bank_mask:0xf
    v_add_f32_dpp v126, v126, v126 row_ror:4 row_mask:0xf bank_mask:0xf
    v_add_f32_dpp v127, v127, v127 row_ror:4 row_mask:0xf bank_mask:0xf
    s_nop 1
    v_add_f32_dpp v112, v112, v112 row_ror:8 row_mask:0xf bank_mask:0xf
    v_add_f32_dpp v113, v113, v113 row_ror:8 row_mask:0xf bank_mask:0xf
    v_add_f32_dpp v114, v114, v114 row_ror:8 row_mask:0xf bank_mask:0xf
    v_add_f32_dpp v115, v115, v115 row_ror:8 row_mask:0xf bank_mask:0xf
    v_add_f32_dpp v116, v116, v116 row_ror:8 row_mask:0xf bank_mask:0xf
    v_add_f32_dpp v117, v117, v117 row_ror:8 row_mask:0xf bank_mask:0xf
    v_add_f32_dpp v118, v118, v118 row_ror:8 row_mask:0xf bank_mask:0xf
    v_add_f32_dpp v119, v119, v119 row_ror:8 row_mask:0xf bank_mask:0xf
    v_add_f32_dpp v120, v120, v120 row_ror:8 row_mask:0xf bank_mask:0xf
    v_add_f32_dpp v121, v121, v121 row_ror:8 row_mask:0xf bank_mask:0xf
    v_add_f32_dpp v122, v122, v122 row_ror:8 row_mask:0xf bank_mask:0xf
    v_add_f32_dpp v123, v123, v123 row_ror:8 row_mask:0xf bank_mask:0xf
    v_add_f32_dpp v124, v124, v124 row_ror:8 row_mask:0xf bank_mask:0xf
    v_add_f32_dpp v125, v125, v125 row_ror:8 row_mask:0xf bank_mask:0xf
    v_add_f32_dpp v126, v126, v126 row_ror:8 row_mask:0xf bank_mask:0xf
    v_add_f32_dpp v127, v127, v127 row_ror:8 row_mask:0xf bank_mask:0xf
    v_lshrrev_b32 v5, 4, v0
    v_lshlrev_b32 v5, 8, v5
    v_lshl_add_u32 v5, v7, 6, v5
    v_cmp_gt_u32 vcc, 4, v4
    s_and_saveexec_b64 s[62:63], vcc
    ds_write_b128 v5, v[112:115] offset:24832
    ds_write_b128 v5, v[116:119] offset:24848
    ds_write_b128 v5, v[120:123] offset:24864
    ds_write_b128 v5, v[124:127] offset:24880
    s_mov_b64 exec, s[62:63]
    s_waitcnt lgkmcnt(0)
    s_barrier
    s_cmp_lg_u32 s60, 0
    s_cbranch_scc1 W0E_30
    v_lshlrev_b32 v5, 2, v0
    ds_read_b32 v96, v5 offset:24832
    ds_read_b32 v97, v5 offset:25088
    ds_read_b32 v98, v5 offset:25344
    ds_read_b32 v99, v5 offset:25600
    ds_read_b32 v100, v5 offset:25856
    ds_read_b32 v101, v5 offset:26112
    ds_read_b32 v102, v5 offset:26368
    ds_read_b32 v103, v5 offset:26624
    ds_read_b32 v104, v5 offset:26880
    ds_read_b32 v105, v5 offset:27136
    ds_read_b32 v106, v5 offset:27392
    ds_read_b32 v107, v5 offset:27648
    ds_read_b32 v108, v5 offset:27904
    ds_read_b32 v109, v5 offset:28160
    ds_read_b32 v110, v5 offset:28416
    ds_read_b32 v111, v5 offset:28672
    ds_read_b32 v112, v5 offset:28928
    ds_read_b32 v113, v5 offset:29184
    ds_read_b32 v114, v5 offset:29440
    ds_read_b32 v115, v5 offset:29696
    ds_read_b32 v116, v5 offset:29952
    ds_read_b32 v117, v5 offset:30208
    ds_read_b32 v118, v5 offset:30464
    ds_read_b32 v119, v5 offset:30720
    ds_read_b32 v120, v5 offset:30976
    ds_read_b32 v121, v5 offset:31232
    ds_read_b32 v122, v5 offset:31488
    ds_read_b32 v123, v5 offset:31744
    ds_read_b32 v124, v5 offset:32000
    ds_read_b32 v125, v5 offset:32256
    ds_read_b32 v126, v5 offset:32512
    ds_read_b32 v127, v5 offset:32768
    s_waitcnt lgkmcnt(0)
    v_add_f32 v96, v96, v97
    v_add_f32 v96, v96, v98
    v_add_f32 v96, v96, v99
    v_add_f32 v96, v96, v100
    v_add_f32 v96, v96, v101
    v_add_f32 v96, v96, v102
    v_add_f32 v96, v96, v103
    v_add_f32 v96, v96, v104
    v_add_f32 v96, v96, v105
    v_add_f32 v96, v96, v106
    v_add_f32 v96, v96, v107
    v_add_f32 v96, v96, v108
    v_add_f32 v96, v96, v109
    v_add_f32 v96, v96, v110
    v_add_f32 v96, v96, v111
    v_add_f32 v96, v96, v112
    v_add_f32 v96, v96, v113
    v_add_f32 v96, v96, v114
    v_add_f32 v96, v96, v115
    v_add_f32 v96, v96, v116
    v_add_f32 v96, v96, v117
    v_add_f32 v96, v96, v118
    v_add_f32 v96, v96, v119
    v_add_f32 v96, v96, v120
    v_add_f32 v96, v96, v121
    v_add_f32 v96, v96, v122
    v_add_f32 v96, v96, v123
    v_add_f32 v96, v96, v124
    v_add_f32 v96, v96, v125
    v_add_f32 v96, v96, v126
    v_add_f32 v96, v96, v127
    v_cvt_pk_bf16_f32 v96, v96, v96
    v_lshlrev_b32 v96, 16, v96
    v_lshlrev_b32 v5, 5, v3
    v_and_b32 v6, 7, v0
    v_lshl_add_u32 v5, v6, 2, v5
    v_bfe_u32 v6, v0, 3, 1
    v_mul_u32_u24 v6, 144, v6
    v_add_u32 v5, v5, v6
    ds_write_b32 v5, v96
    v_mov_b32 v97, 0
    ds_write_b32 v6, v97 offset:128
    s_waitcnt lgkmcnt(0)
W0E_30:
P3OUT:
    s_barrier
    v_lshlrev_b32 v5, 2, v92
    v_min_u32 v5, 8, v5
    ds_read_b32 v96, v5 offset:0
    ds_read_b32 v97, v5 offset:144
    ds_read_b32 v98, v5 offset:12
    ds_read_b32 v99, v5 offset:156
    ds_read_b32 v100, v5 offset:24
    ds_read_b32 v101, v5 offset:168
    ds_read_b32 v102, v5 offset:36
    ds_read_b32 v103, v5 offset:180
    ds_read_b32 v104, v5 offset:48
    ds_read_b32 v105, v5 offset:192
    ds_read_b32 v106, v5 offset:60
    ds_read_b32 v107, v5 offset:204
    ds_read_b32 v108, v5 offset:72
    ds_read_b32 v109, v5 offset:216
    ds_read_b32 v110, v5 offset:84
    ds_read_b32 v111, v5 offset:228
    ds_read_b32 v112, v5 offset:96
    ds_read_b32 v113, v5 offset:240
    ds_read_b32 v114, v5 offset:108
    ds_read_b32 v115, v5 offset:252
    ds_read_b32 v116, v5 offset:120
    ds_read_b32 v117, v5 offset:264
    v_mov_b32 v120, 0
    v_mov_b32 v121, 0
    v_mov_b32 v122, 0
    v_mov_b32 v123, 0
    v_mov_b32 v124, 0
    v_mov_b32 v125, 0
    v_mov_b32 v126, 0
    v_mov_b32 v127, 0
    s_waitcnt vmcnt(0) lgkmcnt(0)
    v_lshlrev_b32 v8, 16, v16
    v_and_b32 v9, 0xffff0000, v16
    v_fmac_f32 v120, v96, v8
    v_fmac_f32 v121, v96, v9
    v_fmac_f32 v124, v97, v8
    v_fmac_f32 v125, v97, v9
    v_lshlrev_b32 v8, 16, v17
    v_and_b32 v9, 0xffff0000, v17
    v_fmac_f32 v122, v96, v8
    v_fmac_f32 v123, v96, v9
    v_fmac_f32 v126, v97, v8
    v_fmac_f32 v127, v97, v9
    v_lshlrev_b32 v8, 16, v18
    v_and_b32 v9, 0xffff0000, v18
    v_fmac_f32 v120, v98, v8
    v_fmac_f32 v121, v98, v9
    v_fmac_f32 v124, v99, v8
    v_fmac_f32 v125, v99, v9
    v_lshlrev_b32 v8, 16, v19
    v_and_b32 v9, 0xffff0000, v19
    v_fmac_f32 v122, v98, v8
    v_fmac_f32 v123, v98, v9
    v_fmac_f32 v126, v99, v8
    v_fmac_f32 v127, v99, v9
    v_lshlrev_b32 v8, 16, v20
    v_and_b32 v9, 0xffff0000, v20
    v_fmac_f32 v120, v100, v8
    v_fmac_f32 v121, v100, v9
    v_fmac_f32 v124, v101, v8
    v_fmac_f32 v125, v101, v9
    v_lshlrev_b32 v8, 16, v21
    v_and_b32 v9, 0xffff0000, v21
    v_fmac_f32 v122, v100, v8
    v_fmac_f32 v123, v100, v9
    v_fmac_f32 v126, v101, v8
    v_fmac_f32 v127, v101, v9
    v_lshlrev_b32 v8, 16, v22
    v_and_b32 v9, 0xffff0000, v22
    v_fmac_f32 v120, v102, v8
    v_fmac_f32 v121, v102, v9
    v_fmac_f32 v124, v103, v8
    v_fmac_f32 v125, v103, v9
    v_lshlrev_b32 v8, 16, v23
    v_and_b32 v9, 0xffff0000, v23
    v_fmac_f32 v122, v102, v8
    v_fmac_f32 v123, v102, v9
    v_fmac_f32 v126, v103, v8
    v_fmac_f32 v127, v103, v9
    v_lshlrev_b32 v8, 16, v24
    v_and_b32 v9, 0xffff0000, v24
    v_fmac_f32 v120, v104, v8
    v_fmac_f32 v121, v104, v9
    v_fmac_f32 v124, v105, v8
    v_fmac_f32 v125, v105, v9
    v_lshlrev_b32 v8, 16, v25
    v_and_b32 v9, 0xffff0000, v25
    v_fmac_f32 v122, v104, v8
    v_fmac_f32 v123, v104, v9
    v_fmac_f32 v126, v105, v8
    v_fmac_f32 v127, v105, v9
    v_lshlrev_b32 v8, 16, v26
    v_and_b32 v9, 0xffff0000, v26
    v_fmac_f32 v120, v106, v8
    v_fmac_f32 v121, v106, v9
    v_fmac_f32 v124, v107, v8
    v_fmac_f32 v125, v107, v9
    v_lshlrev_b32 v8, 16, v27
    v_and_b32 v9, 0xffff0000, v27
    v_fmac_f32 v122, v106, v8
    v_fmac_f32 v123, v106, v9
    v_fmac_f32 v126, v107, v8
    v_fmac_f32 v127, v107, v9
    v_lshlrev_b32 v8, 16, v28
    v_and_b32 v9, 0xffff0000, v28
    v_fmac_f32 v120, v108, v8
    v_fmac_f32 v121, v108, v9
    v_fmac_f32 v124, v109, v8
    v_fmac_f32 v125, v109, v9
    v_lshlrev_b32 v8, 16, v29
    v_and_b32 v9, 0xffff0000, v29
    v_fmac_f32 v122, v108, v8
    v_fmac_f32 v123, v108, v9
    v_fmac_f32 v126, v109, v8
    v_fmac_f32 v127, v109, v9
    v_lshlrev_b32 v8, 16, v30
    v_and_b32 v9, 0xffff0000, v30
    v_fmac_f32 v120, v110, v8
    v_fmac_f32 v121, v110, v9
    v_fmac_f32 v124, v111, v8
    v_fmac_f32 v125, v111, v9
    v_lshlrev_b32 v8, 16, v31
    v_and_b32 v9, 0xffff0000, v31
    v_fmac_f32 v122, v110, v8
    v_fmac_f32 v123, v110, v9
    v_fmac_f32 v126, v111, v8
    v_fmac_f32 v127, v111, v9
    v_lshlrev_b32 v8, 16, v32
    v_and_b32 v9, 0xffff0000, v32
    v_fmac_f32 v120, v112, v8
    v_fmac_f32 v121, v112, v9
    v_fmac_f32 v124, v113, v8
    v_fmac_f32 v125, v113, v9
    v_lshlrev_b32 v8, 16, v33
    v_and_b32 v9, 0xffff0000, v33
    v_fmac_f32 v122, v112, v8
    v_fmac_f32 v123, v112, v9
    v_fmac_f32 v126, v113, v8
    v_fmac_f32 v127, v113, v9
    v_lshlrev_b32 v8, 16, v34
    v_and_b32 v9, 0xffff0000, v34
    v_fmac_f32 v120, v114, v8
    v_fmac_f32 v121, v114, v9
    v_fmac_f32 v124, v115, v8
    v_fmac_f32 v125, v115, v9
    v_lshlrev_b32 v8, 16, v35
    v_and_b32 v9, 0xffff0000, v35
    v_fmac_f32 v122, v114, v8
    v_fmac_f32 v123, v114, v9
    v_fmac_f32 v126, v115, v8
    v_fmac_f32 v127, v115, v9
    v_lshlrev_b32 v8, 16, v36
    v_and_b32 v9, 0xffff0000, v36
    v_fmac_f32 v120, v116, v8
    v_fmac_f32 v121, v116, v9
    v_fmac_f32 v124, v117, v8
    v_fmac_f32 v125, v117, v9
    v_lshlrev_b32 v8, 16, v37
    v_and_b32 v9, 0xffff0000, v37
    v_fmac_f32 v122, v116, v8
    v_fmac_f32 v123, v116, v9
    v_fmac_f32 v126, v117, v8
    v_fmac_f32 v127, v117, v9
    v_mul_u32_u24 v5, 4608, v92
    v_lshl_add_u32 v5, v93, 4, v5
    ds_write_b128 v5, v[120:123] offset:1024
    ds_write_b128 v5, v[124:127] offset:3328
    s_waitcnt lgkmcnt(0)
    s_barrier
    v_cmp_gt_u32 vcc, 0x120, v0
    s_and_saveexec_b64 s[62:63], vcc
    s_cbranch_execz OSK_31
    v_lshlrev_b32 v5, 4, v0
    ds_read_b128 v[96:99], v5 offset:1024
    ds_read_b128 v[100:103], v5 offset:5632
    ds_read_b128 v[104:107], v5 offset:10240
    s_waitcnt lgkmcnt(0)
    v_add_f32 v96, v96, v100
    v_add_f32 v97, v97, v101
    v_add_f32 v98, v98, v102
    v_add_f32 v99, v99, v103
    v_add_f32 v96, v96, v104
    v_add_f32 v97, v97, v105
    v_add_f32 v98, v98, v106
    v_add_f32 v99, v99, v107
    s_mul_i32 s55, s2, 4608
    s_add_u32 s55, s55, 4587520
    buffer_store_dwordx4 v[96:99], v5, s[32:35], s55 offen sc1
OSK_31:
    s_mov_b64 exec, s[62:63]
    s_waitcnt vmcnt(0)
    s_barrier
    s_cmp_lg_u32 s60, 0
    s_cbranch_scc1 W0E_32
    s_and_b32 s55, s2, 3
    s_lshl_b32 s55, s55, 2
    s_add_u32 s55, s55, 228
    s_mov_b64 s[62:63], exec
    s_mov_b64 exec, 1
    v_mov_b32 v5, 1
    v_mov_b32 v6, s55
    v_lshlrev_b32 v6, 5, v6
    v_add_u32 v6, 7864320, v6
    buffer_atomic_add v5, v6, s[32:35], 0 offen
    s_mov_b64 exec, s[62:63]
W0E_32:
    s_cmp_ge_u32 s2, 36
    s_cbranch_scc1 ENDS
    s_cmp_lg_u32 s60, 0
    s_cbranch_scc1 W0E_33
    s_mov_b32 s55, 228
    s_mov_b64 s[62:63], exec
    s_mov_b64 exec, 15
    v_lshlrev_b32 v6, 2, v2
    v_add_u32 v6, s55, v6
    v_lshlrev_b32 v6, 5, v6
    v_add_u32 v6, 7864320, v6
    s_mov_b32 s64, 0
POLL_34:
    buffer_load_dword v5, v6, s[32:35], 0 offen sc1
    s_waitcnt vmcnt(0)
    v_cmp_le_u32 vcc, 64, v5
    s_nop 3
    s_cmp_eq_u64 vcc, exec
    s_cbranch_scc1 PDONE_35
    s_add_u32 s64, s64, 1
    s_cmp_gt_u32 s64, 0x20000
    s_cbranch_scc1 PDONE_35
    s_sleep 2
    s_branch POLL_34
PDONE_35:
    s_mov_b64 exec, s[62:63]
W0E_33:
    s_barrier
    s_cmp_ge_u32 s2, 18
    s_cselect_b32 s56, 1, 0
    s_mul_i32 s57, s56, 18
    s_sub_u32 s57, s2, s57
    s_lshl_b32 s57, s57, 6
    v_add_u32 v7, s57, v2
    s_mul_i32 s55, s56, 589824
    s_add_u32 s55, s55, 4587520
    s_mov_b32 s58, 73728
    v_mul_lo_u32 v8, v1, s58
    v_lshl_add_u32 v8, v7, 2, v8
    buffer_load_dword v96, v8, s[32:35], s55 offen sc1
    s_add_u32 s55, s55, 4608
    buffer_load_dword v97, v8, s[32:35], s55 offen sc1
    s_add_u32 s55, s55, 4608
    buffer_load_dword v98, v8, s[32:35], s55 offen sc1
    s_add_u32 s55, s55, 4608
    buffer_load_dword v99, v8, s[32:35], s55 offen sc1
    s_add_u32 s55, s55, 4608
    buffer_load_dword v100, v8, s[32:35], s55 offen sc1
    s_add_u32 s55, s55, 4608
    buffer_load_dword v101, v8, s[32:35], s55 offen sc1
    s_add_u32 s55, s55, 4608
    buffer_load_dword v102, v8, s[32:35], s55 offen sc1
    s_add_u32 s55, s55, 4608
    buffer_load_dword v103, v8, s[32:35], s55 offen sc1
    s_add_u32 s55, s55, 4608
    buffer_load_dword v104, v8, s[32:35], s55 offen sc1
    s_add_u32 s55, s55, 4608
    buffer_load_dword v105, v8, s[32:35], s55 offen sc1
    s_add_u32 s55, s55, 4608
    buffer_load_dword v106, v8, s[32:35], s55 offen sc1
    s_add_u32 s55, s55, 4608
    buffer_load_dword v107, v8, s[32:35], s55 offen sc1
    s_add_u32 s55, s55, 4608
    buffer_load_dword v108, v8, s[32:35], s55 offen sc1
    s_add_u32 s55, s55, 4608
    buffer_load_dword v109, v8, s[32:35], s55 offen sc1
    s_add_u32 s55, s55, 4608
    buffer_load_dword v110, v8, s[32:35], s55 offen sc1
    s_add_u32 s55, s55, 4608
    buffer_load_dword v111, v8, s[32:35], s55 offen sc1
    s_add_u32 s55, s55, 4608
    s_waitcnt vmcnt(0)
    v_add_f32 v96, v96, v97
    v_add_f32 v96, v96, v98
    v_add_f32 v96, v96, v99
    v_add_f32 v96, v96, v100
    v_add_f32 v96, v96, v101
    v_add_f32 v96, v96, v102
    v_add_f32 v96, v96, v103
    v_add_f32 v96, v96, v104
    v_add_f32 v96, v96, v105
    v_add_f32 v96, v96, v106
    v_add_f32 v96, v96, v107
    v_add_f32 v96, v96, v108
    v_add_f32 v96, v96, v109
    v_add_f32 v96, v96, v110
    v_add_f32 v96, v96, v111
    v_lshlrev_b32 v5, 2, v0
    ds_write_b32 v5, v96 offset:32768
    s_waitcnt lgkmcnt(0)
    s_barrier
    s_cmp_lg_u32 s60, 0
    s_cbranch_scc1 END
    ds_read_b32 v96, v5 offset:32768
    ds_read_b32 v97, v5 offset:33024
    ds_read_b32 v98, v5 offset:33280
    ds_read_b32 v99, v5 offset:33536
    ds_read_b32 v100, v5 offset:33792
    ds_read_b32 v101, v5 offset:34048
    ds_read_b32 v102, v5 offset:34304
    ds_read_b32 v103, v5 offset:34560
    s_waitcnt lgkmcnt(0)
    v_add_f32 v96, v96, v97
    v_add_f32 v96, v96, v98
    v_add_f32 v96, v96, v99
    v_add_f32 v96, v96, v100
    v_add_f32 v96, v96, v101
    v_add_f32 v96, v96, v102
    v_add_f32 v96, v96, v103
    v_cvt_pk_bf16_f32 v96, v96, v96
    v_cmp_le_u32 vcc, 0x240, v7
    v_mov_b32 v6, 0x240
    s_nop 1
    v_cndmask_b32 v6, 0, v6, vcc
    v_add_u32 v6, v6, v7
    s_mul_i32 s58, s56, 576
    v_add_u32 v6, s58, v6
    v_lshlrev_b32 v6, 1, v6
    buffer_store_short v96, v6, s[48:51], 0 offen
ENDS:
END:
    s_endpgm
.section .rodata,"a"
.p2align 6
.amdhsa_kernel concat_heads__gqa_block_cached__compressed_kv_cla__decode_kernel
  .amdhsa_next_free_vgpr 256
  .amdhsa_next_free_sgpr 102
  .amdhsa_accum_offset 256
  .amdhsa_group_segment_fixed_size 0
  .amdhsa_kernarg_size 112
  .amdhsa_user_sgpr_count 2
  .amdhsa_user_sgpr_kernarg_segment_ptr 1
  .amdhsa_system_sgpr_workgroup_id_x 1
.end_amdhsa_kernel
```
